```python
import torch

def _softmax(x, axis=-1):
    return torch.softmax(x, dim=axis)
def _gelu(x):
    return torch.nn.functional.gelu(x, approximate="tanh")
def _silu(x):
    return torch.nn.functional.silu(x)
def _sigmoid(x):
    return torch.sigmoid(x)
def _layernorm(x, axis=-1, eps=1e-5):
    m = x.mean(dim=axis, keepdim=True)
    v = x.var(dim=axis, keepdim=True, unbiased=False)
    return (x - m) / torch.sqrt(v + eps)
def _scatter_add(tgt, idx, src, axis=0):
    return tgt.clone().index_add_(axis, idx, src)
def _segment_sum(src, seg, n):
    out = torch.zeros((n,) + src.shape[1:], dtype=src.dtype)
    return out.index_add_(0, seg, src)
def _pad(x, pw):
    flat = tuple(v for pair in reversed(pw) for v in pair)
    return torch.nn.functional.pad(x, flat)

kernel_name = 'standalone__gqa_block_cached__near_ridge'

def setup_inputs():

    _w = (lambda a: (lambda t: t.to(torch.bfloat16) if t.is_floating_point() else t)(torch.as_tensor(a)))
    B, Sq, D = 8, 48, 1024
    Hq, Hkv, Sk, Dh = 32, 4, 512, 128
    assert Hq % Hkv == 0, (Hq, Hkv)
    return {
        "x": _w((lambda *s: torch.randn(*s, dtype=torch.bfloat16) * 0.8)(B, Sq, D)),
        "k_cache": _w((lambda *s: torch.randn(*s, dtype=torch.bfloat16) * 0.8)(B, Hkv, Sk, Dh)),
        "v_cache": _w((lambda *s: torch.randn(*s, dtype=torch.bfloat16) * 0.05)(B, Hkv, Sk, Dh)),
        "wq": _w((lambda *s: torch.randn(*s, dtype=torch.bfloat16) * 0.8)(D, Hq * Dh) * (D ** -0.5)),
        "wo": _w((lambda *s: torch.randn(*s, dtype=torch.bfloat16) * 0.05)(Hq * Dh, D) * ((Hq * Dh) ** -0.5)),
    }

def reference(x, k_cache, v_cache, wq, wo):
    B, Sq, D = x.shape
    Hq, Dh = 32, 128
    Hkv = k_cache.shape[1]
    rep = Hq // Hkv
    q = (lambda x, *d: x.permute(*d))((x @ wq).reshape(B, Sq, Hq, Dh), 0, 2, 1, 3)
    k = (lambda x, n, axis: torch.repeat_interleave(x, n, dim=axis))(k_cache, rep, axis=1)
    v = (lambda x, n, axis: torch.repeat_interleave(x, n, dim=axis))(v_cache, rep, axis=1)
    scores = torch.einsum("bhqd,bhkd->bhqk", q, k) * (Dh ** -0.5)
    p = _softmax(scores, axis=-1)
    o = torch.einsum("bhqk,bhkd->bhqd", p, v)
    return (lambda x, *d: x.permute(*d))(o, 0, 2, 1, 3).reshape(B, Sq, Hq * Dh) @ wo
```

```asm
; @launch grid=(256,1,1) block=(512,1,1) lds=163840
.amdgcn_target "amdgcn-amd-amdhsa--gfx950"
.text
.globl standalone__gqa_block_cached__near_ridge_kernel
.p2align 8
.type standalone__gqa_block_cached__near_ridge_kernel,@function
standalone__gqa_block_cached__near_ridge_kernel:
  s_load_dwordx2 s[20:21], s[0:1], 0
  s_load_dwordx2 s[32:33], s[0:1], 24
  s_load_dwordx16 s[4:19], s[0:1], 0
  v_readfirstlane_b32 s3, v0
  v_and_b32 v1, 15, v0
  v_bfe_u32 v2, v0, 4, 2
  s_cmp_ge_u32 s2, 256
  s_cbranch_scc1 L_end
  s_lshr_b32 s60, s2, 6
  s_bfe_u32 s54, s2, 0x30003
  s_lshl_b32 s55, s2, 2
  s_and_b32 s58, s55, 4
  s_and_b32 s55, s55, 24
  s_add_u32 s55, s55, s54
  s_add_u32 s52, s58, s60
  s_lshr_b32 s3, s3, 6
  s_cmp_lt_u32 s3, 4
  s_cbranch_scc1 L_comp
  s_sub_u32 s3, s3, 4
  s_mov_b32 s22, 786432
  s_mov_b32 s23, 0x20000
  v_bfe_u32 v6, v0, 4, 4
  v_xor_b32 v7, v6, v1
  v_lshrrev_b32 v14, 3, v7
  v_and_b32 v7, 7, v7
  v_lshlrev_b32 v7, 4, v7
  v_lshl_add_u32 v13, v6, 11, v7
  s_add_u32 s61, s60, s54
  s_add_u32 s49, s61, 1
  s_and_b32 s61, s61, 3
  s_and_b32 s49, s49, 3
  s_add_u32 s61, s61, s58
  s_add_u32 s49, s49, s58
  s_mul_i32 s65, s52, 98304
  s_lshl_b32 s68, s3, 10
  s_sub_i32 s50, s49, s61
  s_lshl_b32 s50, s50, 7
  s_lshl_b32 s51, s61, 7
  v_mad_i32_i24 v12, v14, s50, v13
  s_mov_b32 s62, s65
  v_add_u32 v12, s51, v12
  v_lshlrev_b32 v6, 1, v2
  v_xor_b32 v6, v6, v1
  v_lshlrev_b32 v6, 4, v6
  v_lshl_add_u32 v8, v2, 13, v6
  v_xor_b32 v6, 0x80, v8
  v_add_u32 v9, 31744, v8
  v_add_u32 v10, 63488, v6
  v_add_u32 v11, 95232, v6
  s_lshl_b32 s48, s3, 12
  s_lshl_b32 s64, s3, 9
  s_add_u32 s64, s64, s55
  s_lshl_b32 s64, s64, 8
  s_mov_b32 s34, 8388608
  s_mov_b32 s35, s23
  s_lshl_b32 s61, s61, 19
  s_lshl_b32 s49, s49, 19
  s_add_u32 s61, s61, s64
  s_add_u32 s49, s49, s64
  s_add_u32 m0, s68, 32768
  s_waitcnt lgkmcnt(0)
  buffer_load_dwordx4 v12, s[20:23], s62 offen lds
  s_add_u32 m0, s68, 36864
  s_add_u32 s62, s62, 32768
  buffer_load_dwordx4 v12, s[20:23], s62 offen lds
  s_add_u32 m0, s68, 40960
  s_add_u32 s62, s62, 32768
  buffer_load_dwordx4 v12, s[20:23], s62 offen lds
  s_add_u32 m0, s48, 0
  s_nop 0
  buffer_load_dwordx4 v8, s[32:35], s61 offen offset:0 lds
  buffer_load_dwordx4 v9, s[32:35], s61 offen offset:1024 lds
  buffer_load_dwordx4 v10, s[32:35], s61 offen offset:2048 lds
  buffer_load_dwordx4 v11, s[32:35], s61 offen offset:3072 lds
  s_lshr_b32 s53, s55, 3
  s_and_b32 s59, s2, 1
  s_mov_b32 s99, 0x200000
  v_and_b32 v0, 63, v0
  v_lshlrev_b32 v5, 4, v0
  s_lshl_b32 s67, s3, 13
  s_and_b32 s50, s54, 3
  s_cmp_eq_u32 s50, 1
  s_cselect_b32 s50, 2, 0
  s_lshr_b32 s51, s54, 2
  s_add_u32 s51, s51, s50
  s_mov_b32 s56, 0x5c328410
  s_mov_b32 s57, 0xfedba976
  s_cmp_eq_u32 s51, 1
  s_cselect_b32 s56, 0x65843210, s56
  s_cselect_b32 s57, 0xfedba97c, s57
  s_cmp_eq_u32 s51, 2
  s_cselect_b32 s56, 0x65328410, s56
  s_cselect_b32 s57, 0xfedcba97, s57
  s_cmp_eq_u32 s51, 3
  s_cselect_b32 s56, 0x65843210, s56
  s_cselect_b32 s57, 0xfedcba97, s57
  s_lshl_b32 s94, s51, 2
  s_lshr_b32 s94, 0x43, s94
  s_and_b32 s94, s94, 15
  s_cmp_eq_u32 s3, 0
  s_cselect_b32 s94, s94, 0
  s_and_b32 s63, s54, 3
  s_max_u32 s63, s63, 1
  s_sub_u32 s63, s63, 1
  s_mul_i32 s63, s63, 22
  v_lshrrev_b32 v6, 1, v0
  v_add_u32 v6, s63, v6
  v_min_u32 v6, 63, v6
  v_and_b32 v7, 1, v0
  v_lshlrev_b32 v7, 7, v7
  v_lshl_add_u32 v15, v6, 13, v7
  s_add_u32 s63, s60, 1
  s_and_b32 s63, s63, 3
  s_xor_b32 s0, s58, 12
  s_add_u32 s63, s63, s0
  s_lshl_b32 s63, s63, 11
  s_and_b32 s0, s55, 28
  s_add_u32 s63, s63, s0
  s_add_u32 s63, s63, 1
  s_lshl_b32 s0, s63, 8
  s_add_u32 s50, s60, s54
  s_and_b32 s50, s50, 3
  s_mul_i32 s50, s50, 0x11111111
  s_mul_i32 s51, s59, 0x44444444
  s_and_b32 s63, s56, 0x33333333
  s_xor_b32 s56, s56, s63
  s_xor_b32 s56, s56, s51
  s_add_u32 s63, s63, s50
  s_and_b32 s63, s63, 0x33333333
  s_or_b32 s56, s56, s63
  s_and_b32 s63, s57, 0x33333333
  s_xor_b32 s57, s57, s63
  s_xor_b32 s57, s57, s51
  s_add_u32 s63, s63, s50
  s_and_b32 s63, s63, 0x33333333
  s_or_b32 s57, s57, s63
  s_mov_b32 s24, s6
  s_and_b32 s25, s7, 0xffff
  s_mov_b32 s26, 4194304
  s_mov_b32 s27, 0x20000
  s_mov_b32 s28, s8
  s_and_b32 s29, s9, 0xffff
  s_mov_b32 s30, 4194304
  s_mov_b32 s31, 0x20000
  s_mov_b32 s36, s12
  s_and_b32 s37, s13, 0xffff
  s_mov_b32 s38, 8388608
  s_mov_b32 s39, 0x20000
  s_mov_b32 s44, s18
  s_and_b32 s45, s19, 0xffff
  s_mov_b32 s46, 33554432
  s_mov_b32 s47, 0x20000
  v_add_u32 v6, 0, v2
  v_xor_b32 v6, v6, v1
  v_lshlrev_b32 v6, 4, v6
  v_lshl_add_u32 v16, v2, 8, v6
  v_add_u32 v6, 4, v2
  v_xor_b32 v6, v6, v1
  v_lshlrev_b32 v6, 4, v6
  v_lshl_add_u32 v17, v2, 8, v6
  v_add_u32 v6, 8, v2
  v_xor_b32 v6, v6, v1
  v_lshlrev_b32 v6, 4, v6
  v_lshl_add_u32 v18, v2, 8, v6
  v_add_u32 v6, 12, v2
  v_xor_b32 v6, v6, v1
  v_lshlrev_b32 v6, 4, v6
  v_lshl_add_u32 v19, v2, 8, v6
  v_add_u32 v6, 0, v2
  v_lshlrev_b32 v6, 1, v6
  v_xor_b32 v6, v6, v1
  v_lshlrev_b32 v6, 4, v6
  v_lshl_add_u32 v20, v2, 8, v6
  v_lshl_add_u32 v6, v2, 11, v6
  v_add_u32 v24, 0, v6
  v_add_u32 v26, 14336, v6
  v_add_u32 v6, 4, v2
  v_lshlrev_b32 v6, 1, v6
  v_xor_b32 v6, v6, v1
  v_lshlrev_b32 v6, 4, v6
  v_lshl_add_u32 v21, v2, 8, v6
  v_lshl_add_u32 v6, v2, 11, v6
  v_add_u32 v25, 7168, v6
  v_add_u32 v27, 21504, v6
  s_lshl_b32 s66, s52, 2
  s_add_u32 s66, s66, s53
  s_lshl_b32 s66, s66, 17
  s_lshl_b32 s69, s54, 1
  s_add_u32 s69, s69, s3
  v_and_b32 v6, 3, v0
  v_lshlrev_b32 v6, 8, v6
  v_lshl_add_u32 v6, v0, 2, v6
  v_add_u32 v30, 161792, v6
  v_and_b32 v31, 3, v0
  v_lshlrev_b32 v31, 2, v31
  v_add_u32 v31, 161280, v31
  s_mov_b32 s42, s60
  s_lshl_b32 s71, s53, 3
  s_add_u32 s71, s71, s58
  s_lshl_b32 s71, s71, 18
  s_lshl_b32 s63, s3, 16
  s_add_u32 s71, s71, s63
  s_xor_b32 s63, s54, 3
  s_lshl_b32 s63, s63, 8
  s_add_u32 s71, s71, s63
  s_mul_i32 s70, s52, 12288
  s_lshl_b32 s63, s55, 7
  s_add_u32 s70, s70, s63
  s_add_u32 s70, s70, 12582912
  s_and_b32 s40, s42, 3
  s_lshl_b32 s40, s40, 18
  s_add_u32 s41, s71, s40
  s_add_u32 s43, s41, 32768
  s_and_b32 s40, s54, 4
  s_add_u32 s40, s40, s60
  s_lshl_b32 s40, s40, 2
  s_lshr_b32 s40, 0x77657654, s40
  s_and_b32 s40, s40, 15
  s_lshl_b32 s95, s60, 5
  s_lshl_b32 s60, s3, 2
  s_add_u32 s60, s60, 161280
  s_add_u32 m0, s48, 16384
  s_nop 0
  buffer_load_dwordx4 v8, s[32:35], s49 offen offset:0 lds
  buffer_load_dwordx4 v9, s[32:35], s49 offen offset:1024 lds
  buffer_load_dwordx4 v10, s[32:35], s49 offen offset:2048 lds
  buffer_load_dwordx4 v11, s[32:35], s49 offen offset:3072 lds
  s_bfe_u32 s61, s56, 0x40008
  s_bfe_u32 s49, s56, 0x4000c
  s_sub_i32 s50, s49, s61
  s_lshl_b32 s50, s50, 7
  s_lshl_b32 s51, s61, 7
  v_mad_i32_i24 v12, v14, s50, v13
  s_mov_b32 s62, s65
  v_add_u32 v12, s51, v12
  s_lshl_b32 s61, s61, 19
  s_lshl_b32 s49, s49, 19
  s_add_u32 s61, s61, s64
  s_add_u32 s49, s49, s64
  s_add_u32 m0, s68, 77824
  s_nop 0
  buffer_load_dwordx4 v12, s[20:23], s62 offen lds
  s_add_u32 m0, s68, 81920
  s_add_u32 s62, s62, 32768
  buffer_load_dwordx4 v12, s[20:23], s62 offen lds
  s_add_u32 m0, s68, 86016
  s_add_u32 s62, s62, 32768
  buffer_load_dwordx4 v12, s[20:23], s62 offen lds
  s_add_u32 m0, s48, 45056
  s_nop 0
  buffer_load_dwordx4 v8, s[32:35], s61 offen offset:0 lds
  buffer_load_dwordx4 v9, s[32:35], s61 offen offset:1024 lds
  buffer_load_dwordx4 v10, s[32:35], s61 offen offset:2048 lds
  buffer_load_dwordx4 v11, s[32:35], s61 offen offset:3072 lds
  s_add_u32 m0, s48, 61440
  s_nop 0
  buffer_load_dwordx4 v8, s[32:35], s49 offen offset:0 lds
  s_waitcnt vmcnt(8)
  s_barrier
  buffer_load_dwordx4 v9, s[32:35], s49 offen offset:1024 lds
  buffer_load_dwordx4 v10, s[32:35], s49 offen offset:2048 lds
  buffer_load_dwordx4 v11, s[32:35], s49 offen offset:3072 lds
  s_bfe_u32 s61, s56, 0x40010
  s_bfe_u32 s49, s56, 0x40014
  s_sub_i32 s50, s49, s61
  s_lshl_b32 s50, s50, 7
  s_lshl_b32 s51, s61, 7
  v_mad_i32_i24 v12, v14, s50, v13
  s_mov_b32 s62, s65
  v_add_u32 v12, s51, v12
  s_lshl_b32 s61, s61, 19
  s_lshl_b32 s49, s49, 19
  s_add_u32 s61, s61, s64
  s_add_u32 s49, s49, s64
  s_add_u32 m0, s68, 122880
  s_nop 0
  buffer_load_dwordx4 v12, s[20:23], s62 offen lds
  s_add_u32 m0, s68, 126976
  s_add_u32 s62, s62, 32768
  buffer_load_dwordx4 v12, s[20:23], s62 offen lds
  s_add_u32 m0, s68, 131072
  s_add_u32 s62, s62, 32768
  buffer_load_dwordx4 v12, s[20:23], s62 offen lds
  s_add_u32 m0, s48, 90112
  s_nop 0
  buffer_load_dwordx4 v8, s[32:35], s61 offen offset:0 lds
  buffer_load_dwordx4 v9, s[32:35], s61 offen offset:1024 lds
  buffer_load_dwordx4 v10, s[32:35], s61 offen offset:2048 lds
  buffer_load_dwordx4 v11, s[32:35], s61 offen offset:3072 lds
  s_add_u32 m0, s48, 106496
  s_nop 0
  buffer_load_dwordx4 v8, s[32:35], s49 offen offset:0 lds
  s_waitcnt vmcnt(8)
  s_barrier
  buffer_load_dwordx4 v9, s[32:35], s49 offen offset:1024 lds
  buffer_load_dwordx4 v10, s[32:35], s49 offen offset:2048 lds
  buffer_load_dwordx4 v11, s[32:35], s49 offen offset:3072 lds
  s_bfe_u32 s61, s56, 0x40018
  s_bfe_u32 s49, s56, 0x4001c
  s_sub_i32 s50, s49, s61
  s_lshl_b32 s50, s50, 7
  s_lshl_b32 s51, s61, 7
  v_mad_i32_i24 v12, v14, s50, v13
  s_mov_b32 s62, s65
  v_add_u32 v12, s51, v12
  s_lshl_b32 s61, s61, 19
  s_lshl_b32 s49, s49, 19
  s_add_u32 s61, s61, s64
  s_add_u32 s49, s49, s64
  s_add_u32 m0, s68, 32768
  s_nop 0
  buffer_load_dwordx4 v12, s[20:23], s62 offen lds
  s_add_u32 m0, s68, 36864
  s_add_u32 s62, s62, 32768
  buffer_load_dwordx4 v12, s[20:23], s62 offen lds
  s_add_u32 m0, s68, 40960
  s_add_u32 s62, s62, 32768
  buffer_load_dwordx4 v12, s[20:23], s62 offen lds
  s_add_u32 m0, s48, 0
  s_nop 0
  buffer_load_dwordx4 v8, s[32:35], s61 offen offset:0 lds
  buffer_load_dwordx4 v9, s[32:35], s61 offen offset:1024 lds
  buffer_load_dwordx4 v10, s[32:35], s61 offen offset:2048 lds
  buffer_load_dwordx4 v11, s[32:35], s61 offen offset:3072 lds
  s_add_u32 m0, s48, 16384
  s_nop 0
  buffer_load_dwordx4 v8, s[32:35], s49 offen offset:0 lds
  s_waitcnt vmcnt(8)
  s_barrier
  s_cmp_lg_u32 s94, 3
  s_cbranch_scc1 L_nh3
  s_mov_b32 exec_hi, 0xfff
  buffer_load_dword v33, v15, s[32:35], s0 offen
  s_mov_b64 exec, -1
L_nh3:
  buffer_load_dwordx4 v9, s[32:35], s49 offen offset:1024 lds
  buffer_load_dwordx4 v10, s[32:35], s49 offen offset:2048 lds
  buffer_load_dwordx4 v11, s[32:35], s49 offen offset:3072 lds
  s_cmp_lg_u32 s40, 4
  s_cbranch_scc1 L_nwe4
  buffer_load_dwordx4 v[40:43], v24, s[36:39], s41 offen offset:0
  buffer_load_dwordx4 v[44:47], v25, s[36:39], s41 offen offset:1024
  buffer_load_dwordx4 v[48:51], v26, s[36:39], s41 offen offset:2048
  buffer_load_dwordx4 v[52:55], v27, s[36:39], s41 offen offset:3072
  buffer_load_dwordx4 v[56:59], v24, s[36:39], s43 offen offset:0
L_nwe4:
  s_bfe_u32 s61, s57, 0x40000
  s_bfe_u32 s49, s57, 0x40004
  s_sub_i32 s50, s49, s61
  s_lshl_b32 s50, s50, 7
  s_lshl_b32 s51, s61, 7
  v_mad_i32_i24 v12, v14, s50, v13
  s_mov_b32 s62, s65
  v_add_u32 v12, s51, v12
  s_lshl_b32 s61, s61, 19
  s_lshl_b32 s49, s49, 19
  s_add_u32 s61, s61, s64
  s_add_u32 s49, s49, s64
  s_add_u32 m0, s68, 77824
  s_nop 0
  buffer_load_dwordx4 v12, s[20:23], s62 offen lds
  s_add_u32 m0, s68, 81920
  s_add_u32 s62, s62, 32768
  buffer_load_dwordx4 v12, s[20:23], s62 offen lds
  s_add_u32 m0, s68, 86016
  s_add_u32 s62, s62, 32768
  buffer_load_dwordx4 v12, s[20:23], s62 offen lds
  s_add_u32 m0, s48, 45056
  s_nop 0
  buffer_load_dwordx4 v8, s[32:35], s61 offen offset:0 lds
  buffer_load_dwordx4 v9, s[32:35], s61 offen offset:1024 lds
  buffer_load_dwordx4 v10, s[32:35], s61 offen offset:2048 lds
  buffer_load_dwordx4 v11, s[32:35], s61 offen offset:3072 lds
  s_add_u32 m0, s48, 61440
  s_nop 0
  buffer_load_dwordx4 v8, s[32:35], s49 offen offset:0 lds
  s_waitcnt vmcnt(8)
  s_barrier
  s_cmp_lg_u32 s94, 4
  s_cbranch_scc1 L_nh4
  s_mov_b32 exec_hi, 0xfff
  buffer_load_dword v33, v15, s[32:35], s0 offen
  s_mov_b64 exec, -1
L_nh4:
  buffer_load_dwordx4 v9, s[32:35], s49 offen offset:1024 lds
  buffer_load_dwordx4 v10, s[32:35], s49 offen offset:2048 lds
  buffer_load_dwordx4 v11, s[32:35], s49 offen offset:3072 lds
  s_cmp_lg_u32 s40, 5
  s_cbranch_scc1 L_nwe5
  buffer_load_dwordx4 v[40:43], v24, s[36:39], s41 offen offset:0
  buffer_load_dwordx4 v[44:47], v25, s[36:39], s41 offen offset:1024
  buffer_load_dwordx4 v[48:51], v26, s[36:39], s41 offen offset:2048
  buffer_load_dwordx4 v[52:55], v27, s[36:39], s41 offen offset:3072
  buffer_load_dwordx4 v[56:59], v24, s[36:39], s43 offen offset:0
L_nwe5:
  s_bfe_u32 s61, s57, 0x40008
  s_bfe_u32 s49, s57, 0x4000c
  s_sub_i32 s50, s49, s61
  s_lshl_b32 s50, s50, 7
  s_lshl_b32 s51, s61, 7
  v_mad_i32_i24 v12, v14, s50, v13
  s_mov_b32 s62, s65
  v_add_u32 v12, s51, v12
  s_lshl_b32 s61, s61, 19
  s_lshl_b32 s49, s49, 19
  s_add_u32 s61, s61, s64
  s_add_u32 s49, s49, s64
  s_add_u32 m0, s68, 122880
  s_nop 0
  buffer_load_dwordx4 v12, s[20:23], s62 offen lds
  s_add_u32 m0, s68, 126976
  s_add_u32 s62, s62, 32768
  buffer_load_dwordx4 v12, s[20:23], s62 offen lds
  s_add_u32 m0, s68, 131072
  s_add_u32 s62, s62, 32768
  buffer_load_dwordx4 v12, s[20:23], s62 offen lds
  s_add_u32 m0, s48, 90112
  s_nop 0
  buffer_load_dwordx4 v8, s[32:35], s61 offen offset:0 lds
  buffer_load_dwordx4 v9, s[32:35], s61 offen offset:1024 lds
  buffer_load_dwordx4 v10, s[32:35], s61 offen offset:2048 lds
  buffer_load_dwordx4 v11, s[32:35], s61 offen offset:3072 lds
  s_add_u32 m0, s48, 106496
  s_nop 0
  buffer_load_dwordx4 v8, s[32:35], s49 offen offset:0 lds
  s_waitcnt vmcnt(8)
  s_barrier
  buffer_load_dwordx4 v9, s[32:35], s49 offen offset:1024 lds
  buffer_load_dwordx4 v10, s[32:35], s49 offen offset:2048 lds
  buffer_load_dwordx4 v11, s[32:35], s49 offen offset:3072 lds
  s_cmp_lg_u32 s40, 6
  s_cbranch_scc1 L_nwe6
  buffer_load_dwordx4 v[40:43], v24, s[36:39], s41 offen offset:0
  buffer_load_dwordx4 v[44:47], v25, s[36:39], s41 offen offset:1024
  buffer_load_dwordx4 v[48:51], v26, s[36:39], s41 offen offset:2048
  buffer_load_dwordx4 v[52:55], v27, s[36:39], s41 offen offset:3072
  buffer_load_dwordx4 v[56:59], v24, s[36:39], s43 offen offset:0
L_nwe6:
  s_bfe_u32 s61, s57, 0x40010
  s_bfe_u32 s49, s57, 0x40014
  s_sub_i32 s50, s49, s61
  s_lshl_b32 s50, s50, 7
  s_lshl_b32 s51, s61, 7
  v_mad_i32_i24 v12, v14, s50, v13
  s_mov_b32 s62, s65
  v_add_u32 v12, s51, v12
  s_lshl_b32 s61, s61, 19
  s_lshl_b32 s49, s49, 19
  s_add_u32 s61, s61, s64
  s_add_u32 s49, s49, s64
  s_add_u32 m0, s68, 32768
  s_nop 0
  buffer_load_dwordx4 v12, s[20:23], s62 offen lds
  s_add_u32 m0, s68, 36864
  s_add_u32 s62, s62, 32768
  buffer_load_dwordx4 v12, s[20:23], s62 offen lds
  s_add_u32 m0, s68, 40960
  s_add_u32 s62, s62, 32768
  buffer_load_dwordx4 v12, s[20:23], s62 offen lds
  s_add_u32 m0, s48, 0
  s_nop 0
  buffer_load_dwordx4 v8, s[32:35], s61 offen offset:0 lds
  buffer_load_dwordx4 v9, s[32:35], s61 offen offset:1024 lds
  buffer_load_dwordx4 v10, s[32:35], s61 offen offset:2048 lds
  buffer_load_dwordx4 v11, s[32:35], s61 offen offset:3072 lds
  s_add_u32 m0, s48, 16384
  s_nop 0
  buffer_load_dwordx4 v8, s[32:35], s49 offen offset:0 lds
  s_waitcnt vmcnt(8)
  s_barrier
  buffer_load_dwordx4 v9, s[32:35], s49 offen offset:1024 lds
  buffer_load_dwordx4 v10, s[32:35], s49 offen offset:2048 lds
  buffer_load_dwordx4 v11, s[32:35], s49 offen offset:3072 lds
  s_cmp_lg_u32 s40, 7
  s_cbranch_scc1 L_nwe7
  buffer_load_dwordx4 v[40:43], v24, s[36:39], s41 offen offset:0
  buffer_load_dwordx4 v[44:47], v25, s[36:39], s41 offen offset:1024
  buffer_load_dwordx4 v[48:51], v26, s[36:39], s41 offen offset:2048
  buffer_load_dwordx4 v[52:55], v27, s[36:39], s41 offen offset:3072
  buffer_load_dwordx4 v[56:59], v24, s[36:39], s43 offen offset:0
L_nwe7:
  s_bfe_u32 s61, s57, 0x40018
  s_bfe_u32 s49, s57, 0x4001c
  s_sub_i32 s50, s49, s61
  s_lshl_b32 s50, s50, 7
  s_lshl_b32 s51, s61, 7
  v_mad_i32_i24 v12, v14, s50, v13
  s_mov_b32 s62, s65
  v_add_u32 v12, s51, v12
  s_lshl_b32 s61, s61, 19
  s_lshl_b32 s49, s49, 19
  s_add_u32 s61, s61, s64
  s_add_u32 s49, s49, s64
  s_add_u32 m0, s68, 77824
  s_nop 0
  buffer_load_dwordx4 v12, s[20:23], s62 offen lds
  s_add_u32 m0, s68, 81920
  s_add_u32 s62, s62, 32768
  buffer_load_dwordx4 v12, s[20:23], s62 offen lds
  s_add_u32 m0, s68, 86016
  s_add_u32 s62, s62, 32768
  buffer_load_dwordx4 v12, s[20:23], s62 offen lds
  s_add_u32 m0, s48, 45056
  s_nop 0
  buffer_load_dwordx4 v8, s[32:35], s61 offen offset:0 lds
  buffer_load_dwordx4 v9, s[32:35], s61 offen offset:1024 lds
  buffer_load_dwordx4 v10, s[32:35], s61 offen offset:2048 lds
  buffer_load_dwordx4 v11, s[32:35], s61 offen offset:3072 lds
  s_add_u32 m0, s48, 61440
  s_nop 0
  buffer_load_dwordx4 v8, s[32:35], s49 offen offset:0 lds
  s_waitcnt vmcnt(8)
  s_barrier
  s_load_dwordx8 s[4:11], s[16:17], s95
  buffer_load_dwordx4 v9, s[32:35], s49 offen offset:1024 lds
  buffer_load_dwordx4 v10, s[32:35], s49 offen offset:2048 lds
  buffer_load_dwordx4 v11, s[32:35], s49 offen offset:3072 lds
  s_add_u32 s61, s69, 0
  s_and_b32 s61, s61, 15
  s_lshl_b32 s61, s61, 13
  s_add_u32 m0, s67, 98304
  s_add_u32 s61, s61, s66
  buffer_load_dwordx4 v16, s[24:27], s61 offen offset:0 lds
  buffer_load_dwordx4 v17, s[24:27], s61 offen offset:1024 lds
  buffer_load_dwordx4 v18, s[24:27], s61 offen offset:2048 lds
  buffer_load_dwordx4 v19, s[24:27], s61 offen offset:3072 lds
  s_add_u32 m0, s67, 102400
  s_add_u32 s61, s61, 4096
  buffer_load_dwordx4 v16, s[24:27], s61 offen offset:0 lds
  buffer_load_dwordx4 v17, s[24:27], s61 offen offset:1024 lds
  buffer_load_dwordx4 v18, s[24:27], s61 offen offset:2048 lds
  s_waitcnt vmcnt(7)
  s_barrier
  buffer_load_dwordx4 v19, s[24:27], s61 offen offset:3072 lds
  s_mov_b32 s64, s71
  s_mov_b32 s63, s43
  s_lshl_b32 s61, s53, 3
  s_add_u32 s61, s61, s58
  s_mul_i32 s61, s61, 12288
  s_mul_i32 s65, s52, 393216
  s_add_u32 s65, s65, s61
  s_xor_b32 s43, s52, 4
  s_mul_i32 s43, s43, 393216
  s_add_u32 s43, s43, s61
  s_cmp_lt_u32 s3, 2
  s_mov_b32 s56, 0xec986423
  s_cselect_b32 s56, 0xdafb5710, s56
  s_lshl_b32 s57, s54, 1
  s_and_b32 s49, s48, 4096
  s_add_u32 s49, s49, s66
  s_mov_b32 s20, s18
  s_and_b32 s21, s19, 0xffff
  s_mov_b32 s22, 0
  s_mov_b32 s23, 0x20000
  s_waitcnt lgkmcnt(0)
  s_and_b64 s[4:5], s[4:5], s[6:7]
  s_and_b64 s[8:9], s[8:9], s[10:11]
  s_and_b64 s[4:5], s[4:5], s[8:9]
  s_and_b32 s4, s4, s5
  s_cbranch_scc0 LS_dbg
LK_dbg:
  s_add_u32 s61, s69, 4
  s_and_b32 s61, s61, 15
  s_lshl_b32 s61, s61, 13
  s_add_u32 m0, s67, 0
  s_add_u32 s61, s61, s66
  buffer_load_dwordx4 v16, s[24:27], s61 offen offset:0 lds
  buffer_load_dwordx4 v17, s[24:27], s61 offen offset:1024 lds
  buffer_load_dwordx4 v18, s[24:27], s61 offen offset:2048 lds
  buffer_load_dwordx4 v19, s[24:27], s61 offen offset:3072 lds
  s_add_u32 m0, s67, 4096
  s_add_u32 s61, s61, 4096
  buffer_load_dwordx4 v16, s[24:27], s61 offen offset:0 lds
  buffer_load_dwordx4 v17, s[24:27], s61 offen offset:1024 lds
  buffer_load_dwordx4 v18, s[24:27], s61 offen offset:2048 lds
  s_waitcnt vmcnt(7)
  s_barrier
  buffer_load_dwordx4 v19, s[24:27], s61 offen offset:3072 lds
  s_add_u32 s61, s69, 8
  s_and_b32 s61, s61, 15
  s_lshl_b32 s61, s61, 13
  s_add_u32 m0, s67, 32768
  s_add_u32 s61, s61, s66
  buffer_load_dwordx4 v16, s[24:27], s61 offen offset:0 lds
  buffer_load_dwordx4 v17, s[24:27], s61 offen offset:1024 lds
  buffer_load_dwordx4 v18, s[24:27], s61 offen offset:2048 lds
  buffer_load_dwordx4 v19, s[24:27], s61 offen offset:3072 lds
  s_add_u32 m0, s67, 36864
  s_add_u32 s61, s61, 4096
  buffer_load_dwordx4 v16, s[24:27], s61 offen offset:0 lds
  buffer_load_dwordx4 v17, s[24:27], s61 offen offset:1024 lds
  buffer_load_dwordx4 v18, s[24:27], s61 offen offset:2048 lds
  s_waitcnt vmcnt(7)
  s_barrier
  buffer_load_dwordx4 v19, s[24:27], s61 offen offset:3072 lds
  s_add_u32 s61, s69, 12
  s_and_b32 s61, s61, 15
  s_lshl_b32 s61, s61, 13
  s_add_u32 m0, s67, 65536
  s_add_u32 s61, s61, s66
  buffer_load_dwordx4 v16, s[24:27], s61 offen offset:0 lds
  buffer_load_dwordx4 v17, s[24:27], s61 offen offset:1024 lds
  buffer_load_dwordx4 v18, s[24:27], s61 offen offset:2048 lds
  buffer_load_dwordx4 v19, s[24:27], s61 offen offset:3072 lds
  s_add_u32 m0, s67, 69632
  s_add_u32 s61, s61, 4096
  buffer_load_dwordx4 v16, s[24:27], s61 offen offset:0 lds
  buffer_load_dwordx4 v17, s[24:27], s61 offen offset:1024 lds
  buffer_load_dwordx4 v18, s[24:27], s61 offen offset:2048 lds
  s_waitcnt vmcnt(7)
  s_barrier
  buffer_load_dwordx4 v19, s[24:27], s61 offen offset:3072 lds
  s_lshr_b32 s61, s56, 0
  s_add_u32 s61, s61, s57
  s_and_b32 s61, s61, 15
  s_lshl_b32 s61, s61, 13
  s_add_u32 m0, s48, 98304
  s_add_u32 s61, s61, s49
  buffer_load_dwordx4 v20, s[28:31], s61 offen offset:0 lds
  buffer_load_dwordx4 v21, s[28:31], s61 offen offset:1024 lds
  buffer_load_dwordx4 v20, s[28:31], s61 offen offset:2048 lds
  buffer_load_dwordx4 v21, s[28:31], s61 offen offset:3072 lds
  s_mov_b32 m0, s60
  s_mov_b64 exec, 1
  buffer_load_dword v5, s[20:23], 0 offen offset:384 lds
  s_mov_b64 exec, -1
  s_lshr_b32 s61, s56, 4
  s_add_u32 s61, s61, s57
  s_and_b32 s61, s61, 15
  s_lshl_b32 s61, s61, 13
  s_add_u32 m0, s48, 114688
  s_add_u32 s61, s61, s49
  buffer_load_dwordx4 v20, s[28:31], s61 offen offset:0 lds
  buffer_load_dwordx4 v21, s[28:31], s61 offen offset:1024 lds
  buffer_load_dwordx4 v20, s[28:31], s61 offen offset:2048 lds
  s_waitcnt vmcnt(8)
  s_barrier
  buffer_load_dwordx4 v21, s[28:31], s61 offen offset:3072 lds
  s_mov_b32 m0, s60
  s_mov_b64 exec, 1
  buffer_load_dword v5, s[20:23], 0 offen offset:0 lds
  s_mov_b64 exec, -1
  s_lshl_b32 s61, s53, 3
  s_add_u32 s61, s61, s58
  s_lshl_b32 s61, s61, 7
  s_add_u32 s61, s61, 12582912
  s_xor_b32 s62, s52, 0
  s_mul_i32 s62, s62, 12288
  s_add_u32 s62, s62, s61
  s_add_u32 s12, s18, s62
  s_addc_u32 s13, s19, 0
  s_xor_b32 s62, s52, 4
  s_mul_i32 s62, s62, 12288
  s_add_u32 s62, s62, s61
  s_add_u32 s16, s18, s62
  s_addc_u32 s17, s19, 0
  s_add_u32 s62, s42, 0
  s_and_b32 s62, s62, 3
  s_lshl_b32 s32, s62, 7
  s_add_u32 s62, s42, 1
  s_and_b32 s62, s62, 3
  s_lshl_b32 s33, s62, 7
  s_add_u32 s62, s42, 2
  s_and_b32 s62, s62, 3
  s_lshl_b32 s34, s62, 7
  s_add_u32 s62, s42, 3
  s_and_b32 s62, s62, 3
  s_lshl_b32 s35, s62, 7
  s_lshr_b32 s61, s56, 8
  s_add_u32 s61, s61, s57
  s_and_b32 s61, s61, 15
  s_lshl_b32 s61, s61, 13
  s_add_u32 m0, s48, 0
  s_add_u32 s61, s61, s49
  s_waitcnt vmcnt(6)
  buffer_load_dwordx4 v20, s[28:31], s61 offen offset:0 lds
  s_waitcnt vmcnt(6)
  buffer_load_dwordx4 v21, s[28:31], s61 offen offset:1024 lds
  s_waitcnt vmcnt(6)
  buffer_load_dwordx4 v20, s[28:31], s61 offen offset:2048 lds
  s_waitcnt vmcnt(6)
  buffer_load_dwordx4 v21, s[28:31], s61 offen offset:3072 lds
  s_mov_b32 m0, s60
  s_mov_b64 exec, 1
  buffer_load_dword v5, s[20:23], 0 offen offset:400 lds
  s_mov_b64 exec, -1
  s_lshr_b32 s61, s56, 12
  s_add_u32 s61, s61, s57
  s_and_b32 s61, s61, 15
  s_lshl_b32 s61, s61, 13
  s_add_u32 m0, s48, 16384
  s_add_u32 s61, s61, s49
  s_waitcnt vmcnt(6)
  buffer_load_dwordx4 v20, s[28:31], s61 offen offset:0 lds
  s_waitcnt vmcnt(6)
  buffer_load_dwordx4 v21, s[28:31], s61 offen offset:1024 lds
  s_waitcnt vmcnt(6)
  buffer_load_dwordx4 v20, s[28:31], s61 offen offset:2048 lds
  s_waitcnt vmcnt(6)
  buffer_load_dwordx4 v21, s[28:31], s61 offen offset:3072 lds
  s_mov_b32 m0, s60
  s_mov_b64 exec, 1
  buffer_load_dword v5, s[20:23], 0 offen offset:16 lds
  s_mov_b64 exec, -1
  s_lshr_b32 s61, s56, 16
  s_add_u32 s61, s61, s57
  s_and_b32 s61, s61, 15
  s_lshl_b32 s61, s61, 13
  s_add_u32 m0, s48, 32768
  s_add_u32 s61, s61, s49
  s_waitcnt vmcnt(6)
  buffer_load_dwordx4 v20, s[28:31], s61 offen offset:0 lds
  s_waitcnt vmcnt(6)
  buffer_load_dwordx4 v21, s[28:31], s61 offen offset:1024 lds
  s_waitcnt vmcnt(6)
  buffer_load_dwordx4 v20, s[28:31], s61 offen offset:2048 lds
  s_waitcnt vmcnt(6)
  buffer_load_dwordx4 v21, s[28:31], s61 offen offset:3072 lds
  s_mov_b32 m0, s60
  s_mov_b64 exec, 1
  buffer_load_dword v5, s[20:23], 0 offen offset:416 lds
  s_mov_b64 exec, -1
  s_lshr_b32 s61, s56, 20
  s_add_u32 s61, s61, s57
  s_and_b32 s61, s61, 15
  s_lshl_b32 s61, s61, 13
  s_add_u32 m0, s48, 49152
  s_add_u32 s61, s61, s49
  s_waitcnt vmcnt(6)
  buffer_load_dwordx4 v20, s[28:31], s61 offen offset:0 lds
  s_waitcnt vmcnt(6)
  buffer_load_dwordx4 v21, s[28:31], s61 offen offset:1024 lds
  s_waitcnt vmcnt(6)
  buffer_load_dwordx4 v20, s[28:31], s61 offen offset:2048 lds
  ds_read_b32 v3, v30
  s_waitcnt vmcnt(6)
  buffer_load_dwordx4 v21, s[28:31], s61 offen offset:3072 lds
  s_mov_b32 m0, s60
  s_mov_b64 exec, 1
  buffer_load_dword v5, s[20:23], 0 offen offset:32 lds
  s_mov_b64 exec, -1
  s_waitcnt lgkmcnt(0)
  v_cmp_gt_u32 vcc, 1, v3
  s_cbranch_vccnz LS_l1
LK_l1:
  s_lshr_b32 s61, s56, 24
  s_add_u32 s61, s61, s57
  s_and_b32 s61, s61, 15
  s_lshl_b32 s61, s61, 13
  s_add_u32 m0, s48, 65536
  s_add_u32 s61, s61, s49
  s_waitcnt vmcnt(6)
  buffer_load_dwordx4 v20, s[28:31], s61 offen offset:0 lds
  s_waitcnt vmcnt(6)
  buffer_load_dwordx4 v21, s[28:31], s61 offen offset:1024 lds
  s_waitcnt vmcnt(6)
  buffer_load_dwordx4 v20, s[28:31], s61 offen offset:2048 lds
  s_waitcnt vmcnt(6)
  buffer_load_dwordx4 v21, s[28:31], s61 offen offset:3072 lds
  s_mov_b32 m0, s60
  s_mov_b64 exec, 1
  buffer_load_dword v5, s[20:23], 0 offen offset:432 lds
  s_mov_b64 exec, -1
  s_lshr_b32 s61, s56, 28
  s_add_u32 s61, s61, s57
  s_and_b32 s61, s61, 15
  s_lshl_b32 s61, s61, 13
  s_add_u32 m0, s48, 81920
  s_add_u32 s61, s61, s49
  s_waitcnt vmcnt(6)
  buffer_load_dwordx4 v20, s[28:31], s61 offen offset:0 lds
  s_waitcnt vmcnt(6)
  buffer_load_dwordx4 v21, s[28:31], s61 offen offset:1024 lds
  s_waitcnt vmcnt(6)
  buffer_load_dwordx4 v20, s[28:31], s61 offen offset:2048 lds
  s_waitcnt vmcnt(6)
  buffer_load_dwordx4 v21, s[28:31], s61 offen offset:3072 lds
  s_mov_b32 m0, s60
  s_mov_b64 exec, 1
  buffer_load_dword v5, s[20:23], 0 offen offset:48 lds
  s_mov_b64 exec, -1
  s_add_u32 s61, s42, 0
  s_and_b32 s61, s61, 3
  s_lshl_b32 s61, s61, 18
  s_add_u32 s61, s61, s64
  s_add_u32 s61, s61, 32768
  s_waitcnt vmcnt(6)
  buffer_load_dwordx4 v[60:63], v25, s[36:39], s61 offen offset:1024
  s_waitcnt vmcnt(6)
  buffer_load_dwordx4 v[64:67], v26, s[36:39], s61 offen offset:2048
  s_waitcnt vmcnt(6)
  buffer_load_dwordx4 v[68:71], v27, s[36:39], s61 offen offset:3072
  s_add_u32 s61, s42, 1
  s_and_b32 s61, s61, 3
  s_lshl_b32 s61, s61, 18
  s_add_u32 s61, s61, s64
  s_waitcnt vmcnt(6)
  buffer_load_dwordx4 v[72:75], v24, s[36:39], s61 offen offset:0
  s_waitcnt vmcnt(6)
  buffer_load_dwordx4 v[76:79], v25, s[36:39], s61 offen offset:1024
  s_waitcnt vmcnt(6)
  buffer_load_dwordx4 v[80:83], v26, s[36:39], s61 offen offset:2048
  s_waitcnt vmcnt(6)
  buffer_load_dwordx4 v[84:87], v27, s[36:39], s61 offen offset:3072
  s_add_u32 s61, s61, 32768
  s_waitcnt vmcnt(6)
  buffer_load_dwordx4 v[88:91], v24, s[36:39], s61 offen offset:0
  s_waitcnt vmcnt(6)
  buffer_load_dwordx4 v[92:95], v25, s[36:39], s61 offen offset:1024
  s_waitcnt vmcnt(6)
  buffer_load_dwordx4 v[96:99], v26, s[36:39], s61 offen offset:2048
  s_waitcnt vmcnt(6)
  buffer_load_dwordx4 v[100:103], v27, s[36:39], s61 offen offset:3072
  s_add_u32 s61, s42, 2
  s_and_b32 s61, s61, 3
  s_lshl_b32 s61, s61, 18
  s_add_u32 s61, s61, s64
  s_waitcnt vmcnt(6)
  buffer_load_dwordx4 v[104:107], v24, s[36:39], s61 offen offset:0
  s_waitcnt vmcnt(6)
  buffer_load_dwordx4 v[108:111], v25, s[36:39], s61 offen offset:1024
  s_waitcnt vmcnt(6)
  buffer_load_dwordx4 v[112:115], v26, s[36:39], s61 offen offset:2048
  s_waitcnt vmcnt(6)
  buffer_load_dwordx4 v[116:119], v27, s[36:39], s61 offen offset:3072
  s_add_u32 s61, s61, 32768
  s_waitcnt vmcnt(6)
  buffer_load_dwordx4 v[120:123], v24, s[36:39], s61 offen offset:0
  s_waitcnt vmcnt(6)
  buffer_load_dwordx4 v[124:127], v25, s[36:39], s61 offen offset:1024
  s_waitcnt vmcnt(6)
  buffer_load_dwordx4 v[128:131], v26, s[36:39], s61 offen offset:2048
  s_waitcnt vmcnt(6)
  buffer_load_dwordx4 v[132:135], v27, s[36:39], s61 offen offset:3072
  v_add_u32 v14, s67, v5
  v_add_u32 v15, 0x10000, v14
  v_mov_b32 v34, 0
  v_mov_b32 v35, s60
LW_l2:
  ds_read_b32 v3, v30
  s_waitcnt lgkmcnt(0)
  v_cmp_gt_u32 vcc, 2, v3
  s_sub_u32 s99, s99, 1
  s_cbranch_scc1 L_end
  s_cbranch_vccnz LW_l2
  s_waitcnt vmcnt(23)
  ds_write_b128 v15, v[40:43] offset:32768
  s_waitcnt vmcnt(22)
  ds_write_b128 v15, v[44:47] offset:33792
  s_waitcnt vmcnt(21)
  ds_write_b128 v15, v[48:51] offset:34816
  s_waitcnt vmcnt(20)
  ds_write_b128 v15, v[52:55] offset:35840
  s_waitcnt vmcnt(19)
  ds_write_b128 v15, v[56:59] offset:36864
  s_waitcnt vmcnt(18)
  ds_write_b128 v15, v[60:63] offset:37888
  s_waitcnt vmcnt(17)
  ds_write_b128 v15, v[64:67] offset:38912
  s_waitcnt vmcnt(16)
  ds_write_b128 v15, v[68:71] offset:39936
  s_mov_b64 exec, 1
  ds_write_b32 v35, v34 offset:64
  s_mov_b64 exec, -1
  s_waitcnt vmcnt(15)
  ds_write_b128 v14, v[72:75] offset:0
  s_waitcnt vmcnt(14)
  ds_write_b128 v14, v[76:79] offset:1024
  s_waitcnt vmcnt(13)
  ds_write_b128 v14, v[80:83] offset:2048
  s_waitcnt vmcnt(12)
  ds_write_b128 v14, v[84:87] offset:3072
  s_waitcnt vmcnt(11)
  ds_write_b128 v14, v[88:91] offset:4096
  s_waitcnt vmcnt(10)
  ds_write_b128 v14, v[92:95] offset:5120
  s_waitcnt vmcnt(9)
  ds_write_b128 v14, v[96:99] offset:6144
  s_waitcnt vmcnt(8)
  ds_write_b128 v14, v[100:103] offset:7168
  s_mov_b64 exec, 1
  ds_write_b32 v35, v34 offset:80
  s_mov_b64 exec, -1
  s_waitcnt vmcnt(7)
  ds_write_b128 v14, v[104:107] offset:32768
  s_waitcnt vmcnt(6)
  ds_write_b128 v14, v[108:111] offset:33792
  s_waitcnt vmcnt(5)
  ds_write_b128 v14, v[112:115] offset:34816
  s_waitcnt vmcnt(4)
  ds_write_b128 v14, v[116:119] offset:35840
  s_waitcnt vmcnt(3)
  ds_write_b128 v14, v[120:123] offset:36864
  s_waitcnt vmcnt(2)
  ds_write_b128 v14, v[124:127] offset:37888
  s_waitcnt vmcnt(1)
  ds_write_b128 v14, v[128:131] offset:38912
  s_waitcnt vmcnt(0)
  ds_write_b128 v14, v[132:135] offset:39936
  s_mov_b64 exec, 1
  ds_write_b32 v35, v34 offset:96
  s_mov_b64 exec, -1
LW_l3:
  ds_read_b32 v3, v30
  s_waitcnt lgkmcnt(0)
  v_cmp_gt_u32 vcc, 4, v3
  s_sub_u32 s99, s99, 1
  s_cbranch_scc1 L_end
  s_cbranch_vccnz LW_l3
  s_cmp_lg_u32 s3, 0
  s_cbranch_scc1 L_not0
  s_load_dwordx4 s[4:7], s[12:13], s32 glc
  s_load_dwordx4 s[8:11], s[12:13], s33 glc
  s_load_dwordx4 s[24:27], s[12:13], s34 glc
  s_load_dwordx4 s[28:31], s[12:13], s35 glc
  s_add_u32 s61, s42, 3
  s_and_b32 s61, s61, 3
  s_lshl_b32 s61, s61, 18
  s_add_u32 m0, s67, 65536
  s_add_u32 s61, s61, s64
  s_waitcnt vmcnt(6)
  buffer_load_dwordx4 v24, s[36:39], s61 offen offset:0 lds
  s_waitcnt vmcnt(6)
  buffer_load_dwordx4 v25, s[36:39], s61 offen offset:1024 lds
  s_waitcnt vmcnt(6)
  buffer_load_dwordx4 v26, s[36:39], s61 offen offset:2048 lds
  s_waitcnt vmcnt(6)
  buffer_load_dwordx4 v27, s[36:39], s61 offen offset:3072 lds
  s_add_u32 m0, s67, 69632
  s_add_u32 s61, s61, 32768
  s_waitcnt vmcnt(6)
  buffer_load_dwordx4 v24, s[36:39], s61 offen offset:0 lds
  s_waitcnt vmcnt(6)
  buffer_load_dwordx4 v25, s[36:39], s61 offen offset:1024 lds
  s_waitcnt vmcnt(6)
  buffer_load_dwordx4 v26, s[36:39], s61 offen offset:2048 lds
  s_waitcnt vmcnt(6)
  buffer_load_dwordx4 v27, s[36:39], s61 offen offset:3072 lds
  s_mov_b32 m0, s60
  s_mov_b64 exec, 1
  buffer_load_dword v5, s[20:23], 0 offen offset:112 lds
  s_mov_b64 exec, -1
  s_waitcnt lgkmcnt(0)
  s_and_b32 s61, s4, s5
  s_and_b32 s61, s61, s6
  s_cbranch_scc0 LS_o0
LK_o0:
  s_add_u32 s61, s42, 0
  s_and_b32 s61, s61, 3
  s_mul_i32 s61, s61, 12288
  s_waitcnt vmcnt(24)
  s_mov_b32 m0, 135168
  s_add_u32 s61, s61, s65
  buffer_load_dwordx4 v5, s[44:47], s61 offen offset:0 sc1 lds
  buffer_load_dwordx4 v5, s[44:47], s61 offen offset:1024 sc1 lds
  buffer_load_dwordx4 v5, s[44:47], s61 offen offset:2048 sc1 lds
  buffer_load_dwordx4 v5, s[44:47], s61 offen offset:3072 sc1 lds
  s_waitcnt vmcnt(24)
  s_mov_b32 m0, 139264
  s_add_u32 s61, s61, 4096
  buffer_load_dwordx4 v5, s[44:47], s61 offen offset:0 sc1 lds
  buffer_load_dwordx4 v5, s[44:47], s61 offen offset:1024 sc1 lds
  buffer_load_dwordx4 v5, s[44:47], s61 offen offset:2048 sc1 lds
  buffer_load_dwordx4 v5, s[44:47], s61 offen offset:3072 sc1 lds
  s_waitcnt vmcnt(24)
  s_mov_b32 m0, 143360
  s_add_u32 s61, s61, 4096
  buffer_load_dwordx4 v5, s[44:47], s61 offen offset:0 sc1 lds
  buffer_load_dwordx4 v5, s[44:47], s61 offen offset:1024 sc1 lds
  buffer_load_dwordx4 v5, s[44:47], s61 offen offset:2048 sc1 lds
  buffer_load_dwordx4 v5, s[44:47], s61 offen offset:3072 sc1 lds
  s_mov_b32 m0, 161280
  s_mov_b64 exec, 15
  buffer_load_dword v5, s[20:23], 0 offen offset:144 lds
  s_mov_b64 exec, -1
  s_and_b32 s61, s8, s9
  s_and_b32 s61, s61, s10
  s_cbranch_scc0 LS_o1
LK_o1:
  ds_read_b32 v3, v31 offset:272
  s_add_u32 s61, s42, 1
  s_and_b32 s61, s61, 3
  s_mul_i32 s61, s61, 12288
  s_waitcnt vmcnt(24)
  s_mov_b32 m0, 147456
  s_add_u32 s61, s61, s65
  buffer_load_dwordx4 v5, s[44:47], s61 offen offset:0 sc1 lds
  buffer_load_dwordx4 v5, s[44:47], s61 offen offset:1024 sc1 lds
  buffer_load_dwordx4 v5, s[44:47], s61 offen offset:2048 sc1 lds
  buffer_load_dwordx4 v5, s[44:47], s61 offen offset:3072 sc1 lds
  s_waitcnt vmcnt(24)
  s_mov_b32 m0, 151552
  s_add_u32 s61, s61, 4096
  buffer_load_dwordx4 v5, s[44:47], s61 offen offset:0 sc1 lds
  buffer_load_dwordx4 v5, s[44:47], s61 offen offset:1024 sc1 lds
  buffer_load_dwordx4 v5, s[44:47], s61 offen offset:2048 sc1 lds
  buffer_load_dwordx4 v5, s[44:47], s61 offen offset:3072 sc1 lds
  s_waitcnt vmcnt(24)
  s_mov_b32 m0, 155648
  s_add_u32 s61, s61, 4096
  buffer_load_dwordx4 v5, s[44:47], s61 offen offset:0 sc1 lds
  buffer_load_dwordx4 v5, s[44:47], s61 offen offset:1024 sc1 lds
  buffer_load_dwordx4 v5, s[44:47], s61 offen offset:2048 sc1 lds
  buffer_load_dwordx4 v5, s[44:47], s61 offen offset:3072 sc1 lds
  s_mov_b32 m0, 161280
  s_mov_b64 exec, 15
  buffer_load_dword v5, s[20:23], 0 offen offset:160 lds
  s_mov_b64 exec, -1
  s_waitcnt lgkmcnt(0)
  v_cmp_ne_u32 vcc, 0, v3
  s_cbranch_vccnz LS_l4
LK_l4:
  s_and_b32 s61, s24, s25
  s_and_b32 s61, s61, s26
  s_cbranch_scc0 LS_o2
LK_o2:
  s_add_u32 s61, s42, 2
  s_and_b32 s61, s61, 3
  s_mul_i32 s61, s61, 12288
  s_waitcnt vmcnt(24)
  s_mov_b32 m0, 98304
  s_add_u32 s61, s61, s65
  buffer_load_dwordx4 v5, s[44:47], s61 offen offset:0 sc1 lds
  buffer_load_dwordx4 v5, s[44:47], s61 offen offset:1024 sc1 lds
  buffer_load_dwordx4 v5, s[44:47], s61 offen offset:2048 sc1 lds
  buffer_load_dwordx4 v5, s[44:47], s61 offen offset:3072 sc1 lds
  s_waitcnt vmcnt(24)
  s_mov_b32 m0, 102400
  s_add_u32 s61, s61, 4096
  buffer_load_dwordx4 v5, s[44:47], s61 offen offset:0 sc1 lds
  buffer_load_dwordx4 v5, s[44:47], s61 offen offset:1024 sc1 lds
  buffer_load_dwordx4 v5, s[44:47], s61 offen offset:2048 sc1 lds
  buffer_load_dwordx4 v5, s[44:47], s61 offen offset:3072 sc1 lds
  s_waitcnt vmcnt(24)
  s_mov_b32 m0, 106496
  s_add_u32 s61, s61, 4096
  buffer_load_dwordx4 v5, s[44:47], s61 offen offset:0 sc1 lds
  buffer_load_dwordx4 v5, s[44:47], s61 offen offset:1024 sc1 lds
  buffer_load_dwordx4 v5, s[44:47], s61 offen offset:2048 sc1 lds
  buffer_load_dwordx4 v5, s[44:47], s61 offen offset:3072 sc1 lds
  s_mov_b32 m0, 161280
  s_mov_b64 exec, 15
  buffer_load_dword v5, s[20:23], 0 offen offset:176 lds
  s_mov_b64 exec, -1
  s_and_b32 s61, s28, s29
  s_and_b32 s61, s61, s30
  s_cbranch_scc0 LS_o3
LK_o3:
  s_load_dwordx4 s[4:7], s[16:17], s32 glc
  s_load_dwordx4 s[8:11], s[16:17], s33 glc
  s_load_dwordx4 s[24:27], s[16:17], s34 glc
  s_load_dwordx4 s[28:31], s[16:17], s35 glc
  s_add_u32 s61, s42, 3
  s_and_b32 s61, s61, 3
  s_mul_i32 s61, s61, 12288
  s_waitcnt vmcnt(24)
  s_mov_b32 m0, 110592
  s_add_u32 s61, s61, s65
  buffer_load_dwordx4 v5, s[44:47], s61 offen offset:0 sc1 lds
  buffer_load_dwordx4 v5, s[44:47], s61 offen offset:1024 sc1 lds
  buffer_load_dwordx4 v5, s[44:47], s61 offen offset:2048 sc1 lds
  buffer_load_dwordx4 v5, s[44:47], s61 offen offset:3072 sc1 lds
  s_waitcnt vmcnt(24)
  s_mov_b32 m0, 114688
  s_add_u32 s61, s61, 4096
  buffer_load_dwordx4 v5, s[44:47], s61 offen offset:0 sc1 lds
  buffer_load_dwordx4 v5, s[44:47], s61 offen offset:1024 sc1 lds
  buffer_load_dwordx4 v5, s[44:47], s61 offen offset:2048 sc1 lds
  buffer_load_dwordx4 v5, s[44:47], s61 offen offset:3072 sc1 lds
  s_waitcnt vmcnt(24)
  s_mov_b32 m0, 118784
  s_add_u32 s61, s61, 4096
  buffer_load_dwordx4 v5, s[44:47], s61 offen offset:0 sc1 lds
  buffer_load_dwordx4 v5, s[44:47], s61 offen offset:1024 sc1 lds
  buffer_load_dwordx4 v5, s[44:47], s61 offen offset:2048 sc1 lds
  buffer_load_dwordx4 v5, s[44:47], s61 offen offset:3072 sc1 lds
  s_mov_b32 m0, 161280
  s_mov_b64 exec, 15
  buffer_load_dword v5, s[20:23], 0 offen offset:192 lds
  s_mov_b64 exec, -1
  s_waitcnt lgkmcnt(0)
  s_and_b32 s61, s4, s5
  s_and_b32 s61, s61, s6
  s_cbranch_scc0 LS_o4
LK_o4:
  ds_read_b32 v3, v31 offset:288
  s_add_u32 s61, s42, 4
  s_and_b32 s61, s61, 3
  s_mul_i32 s61, s61, 12288
  s_waitcnt vmcnt(24)
  s_mov_b32 m0, 122880
  s_add_u32 s61, s61, s43
  buffer_load_dwordx4 v5, s[44:47], s61 offen offset:0 sc1 lds
  buffer_load_dwordx4 v5, s[44:47], s61 offen offset:1024 sc1 lds
  buffer_load_dwordx4 v5, s[44:47], s61 offen offset:2048 sc1 lds
  buffer_load_dwordx4 v5, s[44:47], s61 offen offset:3072 sc1 lds
  s_waitcnt vmcnt(24)
  s_mov_b32 m0, 126976
  s_add_u32 s61, s61, 4096
  buffer_load_dwordx4 v5, s[44:47], s61 offen offset:0 sc1 lds
  buffer_load_dwordx4 v5, s[44:47], s61 offen offset:1024 sc1 lds
  buffer_load_dwordx4 v5, s[44:47], s61 offen offset:2048 sc1 lds
  buffer_load_dwordx4 v5, s[44:47], s61 offen offset:3072 sc1 lds
  s_waitcnt vmcnt(24)
  s_mov_b32 m0, 131072
  s_add_u32 s61, s61, 4096
  buffer_load_dwordx4 v5, s[44:47], s61 offen offset:0 sc1 lds
  buffer_load_dwordx4 v5, s[44:47], s61 offen offset:1024 sc1 lds
  buffer_load_dwordx4 v5, s[44:47], s61 offen offset:2048 sc1 lds
  buffer_load_dwordx4 v5, s[44:47], s61 offen offset:3072 sc1 lds
  s_mov_b32 m0, 161280
  s_mov_b64 exec, 15
  buffer_load_dword v5, s[20:23], 0 offen offset:208 lds
  s_mov_b64 exec, -1
  s_waitcnt lgkmcnt(0)
  v_cmp_ne_u32 vcc, 0, v3
  s_cbranch_vccnz LS_l5
LK_l5:
  s_and_b32 s61, s8, s9
  s_and_b32 s61, s61, s10
  s_cbranch_scc0 LS_o5
LK_o5:
  s_add_u32 s61, s42, 5
  s_and_b32 s61, s61, 3
  s_mul_i32 s61, s61, 12288
  s_waitcnt vmcnt(24)
  s_mov_b32 m0, 0
  s_add_u32 s61, s61, s43
  buffer_load_dwordx4 v5, s[44:47], s61 offen offset:0 sc1 lds
  buffer_load_dwordx4 v5, s[44:47], s61 offen offset:1024 sc1 lds
  buffer_load_dwordx4 v5, s[44:47], s61 offen offset:2048 sc1 lds
  buffer_load_dwordx4 v5, s[44:47], s61 offen offset:3072 sc1 lds
  s_waitcnt vmcnt(24)
  s_mov_b32 m0, 4096
  s_add_u32 s61, s61, 4096
  buffer_load_dwordx4 v5, s[44:47], s61 offen offset:0 sc1 lds
  buffer_load_dwordx4 v5, s[44:47], s61 offen offset:1024 sc1 lds
  buffer_load_dwordx4 v5, s[44:47], s61 offen offset:2048 sc1 lds
  buffer_load_dwordx4 v5, s[44:47], s61 offen offset:3072 sc1 lds
  s_waitcnt vmcnt(24)
  s_mov_b32 m0, 8192
  s_add_u32 s61, s61, 4096
  buffer_load_dwordx4 v5, s[44:47], s61 offen offset:0 sc1 lds
  buffer_load_dwordx4 v5, s[44:47], s61 offen offset:1024 sc1 lds
  buffer_load_dwordx4 v5, s[44:47], s61 offen offset:2048 sc1 lds
  buffer_load_dwordx4 v5, s[44:47], s61 offen offset:3072 sc1 lds
  s_mov_b32 m0, 161280
  s_mov_b64 exec, 15
  buffer_load_dword v5, s[20:23], 0 offen offset:224 lds
  s_mov_b64 exec, -1
  s_and_b32 s61, s24, s25
  s_and_b32 s61, s61, s26
  s_cbranch_scc0 LS_o6
LK_o6:
  s_add_u32 s61, s42, 6
  s_and_b32 s61, s61, 3
  s_mul_i32 s61, s61, 12288
  s_waitcnt vmcnt(24)
  s_mov_b32 m0, 12288
  s_add_u32 s61, s61, s43
  buffer_load_dwordx4 v5, s[44:47], s61 offen offset:0 sc1 lds
  buffer_load_dwordx4 v5, s[44:47], s61 offen offset:1024 sc1 lds
  buffer_load_dwordx4 v5, s[44:47], s61 offen offset:2048 sc1 lds
  buffer_load_dwordx4 v5, s[44:47], s61 offen offset:3072 sc1 lds
  s_waitcnt vmcnt(24)
  s_mov_b32 m0, 16384
  s_add_u32 s61, s61, 4096
  buffer_load_dwordx4 v5, s[44:47], s61 offen offset:0 sc1 lds
  buffer_load_dwordx4 v5, s[44:47], s61 offen offset:1024 sc1 lds
  buffer_load_dwordx4 v5, s[44:47], s61 offen offset:2048 sc1 lds
  buffer_load_dwordx4 v5, s[44:47], s61 offen offset:3072 sc1 lds
  s_waitcnt vmcnt(24)
  s_mov_b32 m0, 20480
  s_add_u32 s61, s61, 4096
  buffer_load_dwordx4 v5, s[44:47], s61 offen offset:0 sc1 lds
  buffer_load_dwordx4 v5, s[44:47], s61 offen offset:1024 sc1 lds
  buffer_load_dwordx4 v5, s[44:47], s61 offen offset:2048 sc1 lds
  buffer_load_dwordx4 v5, s[44:47], s61 offen offset:3072 sc1 lds
  s_mov_b32 m0, 161280
  s_mov_b64 exec, 15
  buffer_load_dword v5, s[20:23], 0 offen offset:240 lds
  s_mov_b64 exec, -1
  s_and_b32 s61, s28, s29
  s_and_b32 s61, s61, s30
  s_cbranch_scc0 LS_o7
LK_o7:
  s_add_u32 s61, s42, 7
  s_and_b32 s61, s61, 3
  s_mul_i32 s61, s61, 12288
  s_waitcnt vmcnt(24)
  s_mov_b32 m0, 24576
  s_add_u32 s61, s61, s43
  buffer_load_dwordx4 v5, s[44:47], s61 offen offset:0 sc1 lds
  buffer_load_dwordx4 v5, s[44:47], s61 offen offset:1024 sc1 lds
  buffer_load_dwordx4 v5, s[44:47], s61 offen offset:2048 sc1 lds
  buffer_load_dwordx4 v5, s[44:47], s61 offen offset:3072 sc1 lds
  s_waitcnt vmcnt(24)
  s_mov_b32 m0, 28672
  s_add_u32 s61, s61, 4096
  buffer_load_dwordx4 v5, s[44:47], s61 offen offset:0 sc1 lds
  buffer_load_dwordx4 v5, s[44:47], s61 offen offset:1024 sc1 lds
  buffer_load_dwordx4 v5, s[44:47], s61 offen offset:2048 sc1 lds
  buffer_load_dwordx4 v5, s[44:47], s61 offen offset:3072 sc1 lds
  s_waitcnt vmcnt(24)
  s_mov_b32 m0, 32768
  s_add_u32 s61, s61, 4096
  buffer_load_dwordx4 v5, s[44:47], s61 offen offset:0 sc1 lds
  buffer_load_dwordx4 v5, s[44:47], s61 offen offset:1024 sc1 lds
  buffer_load_dwordx4 v5, s[44:47], s61 offen offset:2048 sc1 lds
  buffer_load_dwordx4 v5, s[44:47], s61 offen offset:3072 sc1 lds
  s_mov_b32 m0, 161280
  s_mov_b64 exec, 15
  buffer_load_dword v5, s[20:23], 0 offen offset:256 lds
  s_mov_b64 exec, -1
  s_branch L_ldone
L_not0:
  s_add_u32 s61, s42, 3
  s_and_b32 s61, s61, 3
  s_lshl_b32 s61, s61, 18
  s_add_u32 m0, s67, 65536
  s_add_u32 s61, s61, s64
  s_waitcnt vmcnt(6)
  buffer_load_dwordx4 v24, s[36:39], s61 offen offset:0 lds
  s_waitcnt vmcnt(6)
  buffer_load_dwordx4 v25, s[36:39], s61 offen offset:1024 lds
  s_waitcnt vmcnt(6)
  buffer_load_dwordx4 v26, s[36:39], s61 offen offset:2048 lds
  s_waitcnt vmcnt(6)
  buffer_load_dwordx4 v27, s[36:39], s61 offen offset:3072 lds
  s_add_u32 m0, s67, 69632
  s_add_u32 s61, s61, 32768
  s_waitcnt vmcnt(6)
  buffer_load_dwordx4 v24, s[36:39], s61 offen offset:0 lds
  s_waitcnt vmcnt(6)
  buffer_load_dwordx4 v25, s[36:39], s61 offen offset:1024 lds
  s_waitcnt vmcnt(6)
  buffer_load_dwordx4 v26, s[36:39], s61 offen offset:2048 lds
  s_waitcnt vmcnt(6)
  buffer_load_dwordx4 v27, s[36:39], s61 offen offset:3072 lds
  s_mov_b32 m0, s60
  s_mov_b64 exec, 1
  buffer_load_dword v5, s[20:23], 0 offen offset:112 lds
  s_mov_b64 exec, -1
  s_mov_b32 s40, s14
  s_and_b32 s41, s15, 0xffff
  s_mov_b32 s42, 786432
  s_mov_b32 s43, 0x20000
  s_sub_u32 s3, s3, 1
  s_xor_b32 s61, s52, 4
  s_mul_i32 s62, s61, 12288
  s_lshl_b32 s63, s55, 7
  s_add_u32 s62, s62, s63
  s_add_u32 s62, s62, 12587008
  s_add_u32 s63, s62, 4096
  s_mul_i32 s64, s61, 3
  s_add_u32 s64, s64, s3
  s_lshl_b32 s64, s64, 15
  s_xor_b32 s65, s54, 3
  s_lshl_b32 s65, s65, 8
  s_add_u32 s64, s64, s65
  s_lshl_b32 s65, s53, 6
  s_add_u32 s64, s64, s65
  s_lshl_b32 s61, s61, 3
  s_add_u32 s61, s61, s54
  s_lshl_b32 s61, s61, 2
  s_add_u32 s61, s61, s53
  s_lshl_b32 s61, s61, 15
  s_add_u32 s61, s61, 4194304
  s_lshl_b32 s65, s3, 10
  v_add_u32 v8, s65, v5
  s_lshl_b32 s65, s3, 20
  s_and_b32 s65, s65, 0xfff
  v_lshl_add_u32 v9, v0, 2, s65
  s_lshl_b32 s65, s3, 11
  s_add_u32 s65, s65, 40960
  v_add_u32 v10, s65, v5
  v_and_b32 v7, 16, v0
  v_lshlrev_b32 v7, 1, v7
  v_lshl_add_u32 v6, v1, 11, v7
  v_lshrrev_b32 v7, 5, v0
  v_lshl_add_u32 v6, v7, 4, v6
  v_mov_b32 v30, v31
LW_l6:
  ds_read_b32 v3, v30 offset:320
  s_waitcnt lgkmcnt(0)
  v_cmp_ne_u32 vcc, 0, v3
  s_sub_u32 s99, s99, 1
  s_cbranch_scc1 L_end
  s_cbranch_vccnz LW_l6
L_epoll:
  s_load_dwordx4 s[4:7], s[18:19], s62 glc
  s_sub_u32 s99, s99, 1
  s_cbranch_scc1 L_end
  s_waitcnt lgkmcnt(0)
  s_and_b64 s[4:5], s[4:5], s[6:7]
  s_and_b32 s4, s4, s5
  s_cbranch_scc0 L_epoll
  s_add_u32 s65, s61, 0
  buffer_load_dword v52, v9, s[44:47], s65 offen offset:3072 sc1
  buffer_load_dwordx4 v[48:51], v8, s[44:47], s65 offen sc1
  s_add_u32 s65, s61, 4096
  buffer_load_dword v60, v9, s[44:47], s65 offen offset:3072 sc1
  buffer_load_dwordx4 v[56:59], v8, s[44:47], s65 offen sc1
  s_add_u32 s65, s61, 8192
  buffer_load_dword v68, v9, s[44:47], s65 offen offset:3072 sc1
  buffer_load_dwordx4 v[64:67], v8, s[44:47], s65 offen sc1
  s_add_u32 s65, s61, 12288
  buffer_load_dword v76, v9, s[44:47], s65 offen offset:3072 sc1
  buffer_load_dwordx4 v[72:75], v8, s[44:47], s65 offen sc1
L_lpoll:
  s_load_dwordx4 s[4:7], s[18:19], s63 glc
  s_sub_u32 s99, s99, 1
  s_cbranch_scc1 L_end
  s_waitcnt lgkmcnt(0)
  s_and_b32 s4, s4, s5
  s_and_b32 s4, s4, s6
  s_cbranch_scc0 L_lpoll
L_lok:
  s_add_u32 s65, s61, 16384
  buffer_load_dword v84, v9, s[44:47], s65 offen offset:3072 sc1
  buffer_load_dwordx4 v[80:83], v8, s[44:47], s65 offen sc1
  s_add_u32 s65, s61, 20480
  buffer_load_dword v92, v9, s[44:47], s65 offen offset:3072 sc1
  buffer_load_dwordx4 v[88:91], v8, s[44:47], s65 offen sc1
  s_add_u32 s65, s61, 24576
  buffer_load_dword v100, v9, s[44:47], s65 offen offset:3072 sc1
  buffer_load_dwordx4 v[96:99], v8, s[44:47], s65 offen sc1
LW_l7:
  ds_read_b32 v3, v30 offset:320
  ds_read_b128 v[40:43], v10
  ds_read_b128 v[44:47], v10 offset:1024
  s_waitcnt lgkmcnt(2)
  v_cmp_ne_u32 vcc, 0, v3
  s_sub_u32 s99, s99, 1
  s_cbranch_scc1 L_end
  s_cbranch_vccnz LW_l7
  s_waitcnt vmcnt(12)
  s_waitcnt lgkmcnt(1)
  v_fma_mix_f32 v40, v48, v52, v40 op_sel:[0,0,0] op_sel_hi:[1,0,0]
  v_fma_mix_f32 v41, v48, v52, v41 op_sel:[1,0,0] op_sel_hi:[1,0,0]
  v_fma_mix_f32 v42, v49, v52, v42 op_sel:[0,0,0] op_sel_hi:[1,0,0]
  v_fma_mix_f32 v43, v49, v52, v43 op_sel:[1,0,0] op_sel_hi:[1,0,0]
  s_waitcnt lgkmcnt(0)
  v_fma_mix_f32 v44, v50, v52, v44 op_sel:[0,0,0] op_sel_hi:[1,0,0]
  v_fma_mix_f32 v45, v50, v52, v45 op_sel:[1,0,0] op_sel_hi:[1,0,0]
  v_fma_mix_f32 v46, v51, v52, v46 op_sel:[0,0,0] op_sel_hi:[1,0,0]
  v_fma_mix_f32 v47, v51, v52, v47 op_sel:[1,0,0] op_sel_hi:[1,0,0]
  s_waitcnt vmcnt(10)
  v_fma_mix_f32 v40, v56, v60, v40 op_sel:[0,0,0] op_sel_hi:[1,0,0]
  v_fma_mix_f32 v41, v56, v60, v41 op_sel:[1,0,0] op_sel_hi:[1,0,0]
  v_fma_mix_f32 v42, v57, v60, v42 op_sel:[0,0,0] op_sel_hi:[1,0,0]
  v_fma_mix_f32 v43, v57, v60, v43 op_sel:[1,0,0] op_sel_hi:[1,0,0]
  v_fma_mix_f32 v44, v58, v60, v44 op_sel:[0,0,0] op_sel_hi:[1,0,0]
  v_fma_mix_f32 v45, v58, v60, v45 op_sel:[1,0,0] op_sel_hi:[1,0,0]
  v_fma_mix_f32 v46, v59, v60, v46 op_sel:[0,0,0] op_sel_hi:[1,0,0]
  v_fma_mix_f32 v47, v59, v60, v47 op_sel:[1,0,0] op_sel_hi:[1,0,0]
  s_waitcnt vmcnt(8)
  v_fma_mix_f32 v40, v64, v68, v40 op_sel:[0,0,0] op_sel_hi:[1,0,0]
  v_fma_mix_f32 v41, v64, v68, v41 op_sel:[1,0,0] op_sel_hi:[1,0,0]
  v_fma_mix_f32 v42, v65, v68, v42 op_sel:[0,0,0] op_sel_hi:[1,0,0]
  v_fma_mix_f32 v43, v65, v68, v43 op_sel:[1,0,0] op_sel_hi:[1,0,0]
  v_fma_mix_f32 v44, v66, v68, v44 op_sel:[0,0,0] op_sel_hi:[1,0,0]
  v_fma_mix_f32 v45, v66, v68, v45 op_sel:[1,0,0] op_sel_hi:[1,0,0]
  v_fma_mix_f32 v46, v67, v68, v46 op_sel:[0,0,0] op_sel_hi:[1,0,0]
  v_fma_mix_f32 v47, v67, v68, v47 op_sel:[1,0,0] op_sel_hi:[1,0,0]
  s_waitcnt vmcnt(6)
  v_fma_mix_f32 v40, v72, v76, v40 op_sel:[0,0,0] op_sel_hi:[1,0,0]
  v_fma_mix_f32 v41, v72, v76, v41 op_sel:[1,0,0] op_sel_hi:[1,0,0]
  v_fma_mix_f32 v42, v73, v76, v42 op_sel:[0,0,0] op_sel_hi:[1,0,0]
  v_fma_mix_f32 v43, v73, v76, v43 op_sel:[1,0,0] op_sel_hi:[1,0,0]
  v_fma_mix_f32 v44, v74, v76, v44 op_sel:[0,0,0] op_sel_hi:[1,0,0]
  v_fma_mix_f32 v45, v74, v76, v45 op_sel:[1,0,0] op_sel_hi:[1,0,0]
  v_fma_mix_f32 v46, v75, v76, v46 op_sel:[0,0,0] op_sel_hi:[1,0,0]
  v_fma_mix_f32 v47, v75, v76, v47 op_sel:[1,0,0] op_sel_hi:[1,0,0]
  s_waitcnt vmcnt(4)
  v_fma_mix_f32 v40, v80, v84, v40 op_sel:[0,0,0] op_sel_hi:[1,0,0]
  v_fma_mix_f32 v41, v80, v84, v41 op_sel:[1,0,0] op_sel_hi:[1,0,0]
  v_fma_mix_f32 v42, v81, v84, v42 op_sel:[0,0,0] op_sel_hi:[1,0,0]
  v_fma_mix_f32 v43, v81, v84, v43 op_sel:[1,0,0] op_sel_hi:[1,0,0]
  v_fma_mix_f32 v44, v82, v84, v44 op_sel:[0,0,0] op_sel_hi:[1,0,0]
  v_fma_mix_f32 v45, v82, v84, v45 op_sel:[1,0,0] op_sel_hi:[1,0,0]
  v_fma_mix_f32 v46, v83, v84, v46 op_sel:[0,0,0] op_sel_hi:[1,0,0]
  v_fma_mix_f32 v47, v83, v84, v47 op_sel:[1,0,0] op_sel_hi:[1,0,0]
  s_waitcnt vmcnt(2)
  v_fma_mix_f32 v40, v88, v92, v40 op_sel:[0,0,0] op_sel_hi:[1,0,0]
  v_fma_mix_f32 v41, v88, v92, v41 op_sel:[1,0,0] op_sel_hi:[1,0,0]
  v_fma_mix_f32 v42, v89, v92, v42 op_sel:[0,0,0] op_sel_hi:[1,0,0]
  v_fma_mix_f32 v43, v89, v92, v43 op_sel:[1,0,0] op_sel_hi:[1,0,0]
  v_fma_mix_f32 v44, v90, v92, v44 op_sel:[0,0,0] op_sel_hi:[1,0,0]
  v_fma_mix_f32 v45, v90, v92, v45 op_sel:[1,0,0] op_sel_hi:[1,0,0]
  v_fma_mix_f32 v46, v91, v92, v46 op_sel:[0,0,0] op_sel_hi:[1,0,0]
  v_fma_mix_f32 v47, v91, v92, v47 op_sel:[1,0,0] op_sel_hi:[1,0,0]
  s_waitcnt vmcnt(0)
  v_fma_mix_f32 v40, v96, v100, v40 op_sel:[0,0,0] op_sel_hi:[1,0,0]
  v_fma_mix_f32 v41, v96, v100, v41 op_sel:[1,0,0] op_sel_hi:[1,0,0]
  v_fma_mix_f32 v42, v97, v100, v42 op_sel:[0,0,0] op_sel_hi:[1,0,0]
  v_fma_mix_f32 v43, v97, v100, v43 op_sel:[1,0,0] op_sel_hi:[1,0,0]
  v_fma_mix_f32 v44, v98, v100, v44 op_sel:[0,0,0] op_sel_hi:[1,0,0]
  v_fma_mix_f32 v45, v98, v100, v45 op_sel:[1,0,0] op_sel_hi:[1,0,0]
  v_fma_mix_f32 v46, v99, v100, v46 op_sel:[0,0,0] op_sel_hi:[1,0,0]
  v_fma_mix_f32 v47, v99, v100, v47 op_sel:[1,0,0] op_sel_hi:[1,0,0]
  v_cvt_pk_bf16_f32 v40, v40, v41
  v_cvt_pk_bf16_f32 v41, v42, v43
  v_cvt_pk_bf16_f32 v42, v44, v45
  v_cvt_pk_bf16_f32 v43, v46, v47
  s_nop 0
  v_permlane16_swap_b32 v40, v42
  v_permlane16_swap_b32 v41, v43
  buffer_store_dwordx4 v[40:43], v6, s[40:43], s64 offen
  s_endpgm
L_ldone:
  s_waitcnt vmcnt(0) lgkmcnt(0)
L_end:
  s_endpgm
LS_dbg:
  v_and_b32 v6, 7, v0
  v_lshl_add_u32 v6, v6, 2, s95
LS_dbg2:
  global_load_dword v7, v6, s[16:17] sc1
  s_sub_u32 s99, s99, 1
  s_cbranch_scc1 L_end
  s_waitcnt vmcnt(0)
  v_cmp_eq_u32 vcc, 0, v7
  s_cbranch_vccnz LS_dbg2
  s_branch LK_dbg
LS_l1:
  ds_read_b32 v3, v30
  s_waitcnt lgkmcnt(0)
  v_cmp_gt_u32 vcc, 1, v3
  s_sub_u32 s99, s99, 1
  s_cbranch_scc1 L_end
  s_cbranch_vccnz LS_l1
  s_branch LK_l1
LS_o0:
  s_load_dwordx4 s[4:7], s[12:13], s32 glc
  s_load_dwordx4 s[8:11], s[12:13], s33 glc
  s_load_dwordx4 s[24:27], s[12:13], s34 glc
  s_load_dwordx4 s[28:31], s[12:13], s35 glc
  s_sub_u32 s99, s99, 1
  s_cbranch_scc1 L_end
  s_waitcnt lgkmcnt(0)
  s_and_b32 s61, s4, s5
  s_and_b32 s61, s61, s6
  s_cbranch_scc0 LS_o0
  s_branch LK_o0
LS_o1:
  s_load_dwordx4 s[8:11], s[12:13], s33 glc
  s_load_dwordx4 s[24:27], s[12:13], s34 glc
  s_load_dwordx4 s[28:31], s[12:13], s35 glc
  s_sub_u32 s99, s99, 1
  s_cbranch_scc1 L_end
  s_waitcnt lgkmcnt(0)
  s_and_b32 s61, s8, s9
  s_and_b32 s61, s61, s10
  s_cbranch_scc0 LS_o1
  s_branch LK_o1
LS_l4:
  ds_read_b32 v3, v31 offset:272
  s_waitcnt lgkmcnt(0)
  v_cmp_ne_u32 vcc, 0, v3
  s_sub_u32 s99, s99, 1
  s_cbranch_scc1 L_end
  s_cbranch_vccnz LS_l4
  s_branch LK_l4
LS_o2:
  s_load_dwordx4 s[24:27], s[12:13], s34 glc
  s_load_dwordx4 s[28:31], s[12:13], s35 glc
  s_sub_u32 s99, s99, 1
  s_cbranch_scc1 L_end
  s_waitcnt lgkmcnt(0)
  s_and_b32 s61, s24, s25
  s_and_b32 s61, s61, s26
  s_cbranch_scc0 LS_o2
  s_branch LK_o2
LS_o3:
  s_load_dwordx4 s[28:31], s[12:13], s35 glc
  s_sub_u32 s99, s99, 1
  s_cbranch_scc1 L_end
  s_waitcnt lgkmcnt(0)
  s_and_b32 s61, s28, s29
  s_and_b32 s61, s61, s30
  s_cbranch_scc0 LS_o3
  s_branch LK_o3
LS_o4:
  s_load_dwordx4 s[4:7], s[16:17], s32 glc
  s_load_dwordx4 s[8:11], s[16:17], s33 glc
  s_load_dwordx4 s[24:27], s[16:17], s34 glc
  s_load_dwordx4 s[28:31], s[16:17], s35 glc
  s_sub_u32 s99, s99, 1
  s_cbranch_scc1 L_end
  s_waitcnt lgkmcnt(0)
  s_and_b32 s61, s4, s5
  s_and_b32 s61, s61, s6
  s_cbranch_scc0 LS_o4
  s_branch LK_o4
LS_l5:
  ds_read_b32 v3, v31 offset:288
  s_waitcnt lgkmcnt(0)
  v_cmp_ne_u32 vcc, 0, v3
  s_sub_u32 s99, s99, 1
  s_cbranch_scc1 L_end
  s_cbranch_vccnz LS_l5
  s_branch LK_l5
LS_o5:
  s_load_dwordx4 s[8:11], s[16:17], s33 glc
  s_load_dwordx4 s[24:27], s[16:17], s34 glc
  s_load_dwordx4 s[28:31], s[16:17], s35 glc
  s_sub_u32 s99, s99, 1
  s_cbranch_scc1 L_end
  s_waitcnt lgkmcnt(0)
  s_and_b32 s61, s8, s9
  s_and_b32 s61, s61, s10
  s_cbranch_scc0 LS_o5
  s_branch LK_o5
LS_o6:
  s_load_dwordx4 s[24:27], s[16:17], s34 glc
  s_load_dwordx4 s[28:31], s[16:17], s35 glc
  s_sub_u32 s99, s99, 1
  s_cbranch_scc1 L_end
  s_waitcnt lgkmcnt(0)
  s_and_b32 s61, s24, s25
  s_and_b32 s61, s61, s26
  s_cbranch_scc0 LS_o6
  s_branch LK_o6
LS_o7:
  s_load_dwordx4 s[28:31], s[16:17], s35 glc
  s_sub_u32 s99, s99, 1
  s_cbranch_scc1 L_end
  s_waitcnt lgkmcnt(0)
  s_and_b32 s61, s28, s29
  s_and_b32 s61, s61, s30
  s_cbranch_scc0 LS_o7
  s_branch LK_o7
L_comp:
  s_lshr_b32 s53, s55, 3
  s_and_b32 s59, s2, 1
  s_mov_b32 s99, 0x200000
  v_and_b32 v0, 63, v0
  v_lshlrev_b32 v5, 4, v0
  s_getpc_b64 s[60:61]
L_pc:
  s_sub_u32 s60, s60, L_pc - standalone__gqa_block_cached__near_ridge_kernel
  s_subb_u32 s61, s61, 0
  s_lshr_b32 s62, s2, 3
  s_mul_i32 s62, s62, 1152
  v_lshl_add_u32 v39, v0, 7, s62
  v_min_u32 v39, 0x7d00, v39
  v_mov_b32 v155, s61
  v_add_co_u32 v154, vcc, s60, v39
  s_nop 1
  v_addc_co_u32 v155, vcc, 0, v155, vcc
  s_cmp_lg_u32 s3, 0
  s_cbranch_scc1 L_nopf
  s_mov_b64 exec, 511
  global_load_dword v159, v[154:155], off
  s_mov_b64 exec, -1
L_nopf:
  v_mov_b32 v40, 0
  v_mov_b32 v41, 0
  v_mov_b32 v42, 0
  v_mov_b32 v43, 0
  s_xor_b32 s28, s3, 1
  s_xor_b32 s61, s54, 4
  s_or_b32 s28, s28, s61
  v_bfe_u32 v3, v0, 2, 2
  v_and_b32 v4, 3, v0
  s_lshl_b32 s61, s3, 1
  v_and_b32 v36, 1, v2
  v_lshlrev_b32 v36, 2, v36
  v_or_b32 v36, v36, v3
  v_lshlrev_b32 v37, 3, v2
  v_add_u32 v37, v37, v3
  v_lshlrev_b32 v37, 8, v37
  v_lshl_add_u32 v37, v4, 3, v37
  s_add_u32 s62, s61, 0
  v_xor_b32 v38, s62, v36
  v_lshl_add_u32 v6, v38, 5, v37
  s_add_u32 s62, s61, 1
  v_xor_b32 v38, s62, v36
  v_lshl_add_u32 v7, v38, 5, v37
  v_add_u32 v38, 0, v2
  v_xor_b32 v38, v38, v1
  v_lshlrev_b32 v38, 4, v38
  v_lshl_add_u32 v8, v1, 8, v38
  v_add_u32 v38, 4, v2
  v_xor_b32 v38, v38, v1
  v_lshlrev_b32 v38, 4, v38
  v_lshl_add_u32 v9, v1, 8, v38
  v_add_u32 v38, 8, v2
  v_xor_b32 v38, v38, v1
  v_lshlrev_b32 v38, 4, v38
  v_lshl_add_u32 v10, v1, 8, v38
  v_add_u32 v38, 12, v2
  v_xor_b32 v38, v38, v1
  v_lshlrev_b32 v38, 4, v38
  v_lshl_add_u32 v11, v1, 8, v38
  v_lshlrev_b32 v37, 2, v2
  v_add_u32 v37, v37, v3
  v_and_b32 v36, 7, v37
  v_lshlrev_b32 v37, 8, v37
  v_lshl_add_u32 v37, v4, 3, v37
  v_xor_b32 v38, 0, v36
  v_lshl_add_u32 v140, v38, 5, v37
  v_add_u32 v18, 0x10000, v140
  v_xor_b32 v38, 1, v36
  v_lshl_add_u32 v141, v38, 5, v37
  v_add_u32 v19, 0x10000, v141
  v_xor_b32 v38, 2, v36
  v_lshl_add_u32 v142, v38, 5, v37
  v_add_u32 v20, 0x10000, v142
  v_xor_b32 v38, 3, v36
  v_lshl_add_u32 v143, v38, 5, v37
  v_add_u32 v21, 0x10000, v143
  v_xor_b32 v38, 4, v36
  v_lshl_add_u32 v144, v38, 5, v37
  v_add_u32 v22, 0x10000, v144
  v_xor_b32 v38, 5, v36
  v_lshl_add_u32 v145, v38, 5, v37
  v_add_u32 v23, 0x10000, v145
  v_xor_b32 v38, 6, v36
  v_lshl_add_u32 v146, v38, 5, v37
  v_add_u32 v24, 0x10000, v146
  v_xor_b32 v38, 7, v36
  v_lshl_add_u32 v147, v38, 5, v37
  v_add_u32 v25, 0x10000, v147
  s_add_u32 s62, s61, 0
  v_xor_b32 v38, s62, v36
  v_lshl_add_u32 v28, v38, 5, v37
  v_add_u32 v26, 0x10000, v28
  s_add_u32 s62, s61, 1
  v_xor_b32 v38, s62, v36
  v_lshl_add_u32 v29, v38, 5, v37
  v_add_u32 v27, 0x10000, v29
  v_lshlrev_b32 v30, 2, v4
  v_add_u32 v30, 161280, v30
  s_lshl_b32 s62, s3, 9
  s_cmp_eq_u32 s3, 3
  s_cselect_b32 s62, 0, s62
  s_add_u32 s62, s62, 159744
  v_lshl_add_u32 v31, v0, 3, s62
  s_lshl_b32 s62, s3, 8
  s_add_u32 s62, s62, 161792
  v_lshl_add_u32 v32, v0, 2, s62
  v_add_u32 v33, 98304, v5
  s_lshl_b32 s62, s3, 13
  s_add_u32 s62, s62, 135168
  v_add_u32 v34, s62, v5
  v_lshrrev_b32 v36, 1, v2
  v_lshlrev_b32 v36, 8, v36
  v_lshl_add_u32 v36, v1, 4, v36
  v_and_b32 v37, 1, v2
  v_lshl_add_u32 v36, v37, 3, v36
  s_lshl_b32 s62, s3, 10
  s_add_u32 s62, s62, 135168
  v_add_u32 v35, s62, v36
  v_add_u32 v2, 135168, v5
  s_lshl_b32 s62, s3, 12
  v_add_u32 v1, s62, v2
  v_mov_b32 v148, 0x3f803f80
  v_mov_b32 v149, 0x3f803f80
  v_mov_b32 v150, 0x3f803f80
  v_mov_b32 v151, 0x3f803f80
  v_mov_b32 v4, 1
  v_lshlrev_b32 v37, 2, v0
  v_add_u32 v38, 161280, v37
  ds_write_b64 v31, v[40:41]
  ds_write_b32 v32, v40
  ds_write_b32 v38, v4
  ds_write_b32 v38, v4 offset:256
  ds_write_b32 v38, v40 offset:1536
  ds_write_b32 v38, v40 offset:1792
  ds_write_b32 v38, v40 offset:2048
  ds_write_b32 v38, v40 offset:2304
  s_waitcnt lgkmcnt(0)
  s_mov_b32 s44, s18
  s_and_b32 s45, s19, 0xffff
  s_mov_b32 s46, 33554432
  s_mov_b32 s47, 0x20000
  s_mov_b32 s48, s16
  s_and_b32 s49, s17, 0xffff
  s_mov_b32 s50, 256
  s_mov_b32 s51, 0x20000
  s_mov_b32 s20, s18
  s_and_b32 s21, s19, 0xffff
  s_mov_b32 s22, 0
  s_mov_b32 s23, 0x20000
  s_cmp_lg_u32 s28, 0
  s_cbranch_scc1 L_nolead
  s_mul_i32 s62, s52, 12288
  s_lshl_b32 s61, s53, 10
  s_add_u32 s62, s62, s61
  s_add_u32 s62, s62, 12582912
  s_waitcnt lgkmcnt(0)
  s_mov_b32 s44, s18
  s_and_b32 s45, s19, 0xffff
  s_mov_b32 s46, 33554432
  s_mov_b32 s47, 0x20000
  buffer_store_dwordx4 v[40:43], v5, s[44:47], s62 offen sc1
  s_add_u32 s62, s62, 4096
  buffer_store_dwordx4 v[40:43], v5, s[44:47], s62 offen sc1
  s_add_u32 s62, s62, 4096
  buffer_store_dwordx4 v[40:43], v5, s[44:47], s62 offen sc1
L_nolead:
  s_and_b32 s29, s52, 3
  s_lshl_b32 s29, s29, 3
  s_add_u32 s29, s29, s58
  s_add_u32 s29, s29, s53
  s_lshl_b32 s29, s29, 2
  s_mov_b32 s63, 0x3e0293ee
  s_lshl_b32 s60, s52, 5
  s_add_u32 s60, s60, s55
  s_mul_i32 s60, s60, 3
  s_add_u32 s60, s60, s3
  s_lshl_b32 s60, s60, 12
  s_and_b32 s61, s52, 3
  s_and_b32 s62, s54, 4
  s_add_u32 s62, s62, s61
  s_mul_i32 s62, s62, 12288
  s_sub_u32 s61, s54, s52
  s_and_b32 s61, s61, 3
  s_xor_b32 s56, s54, s52
  s_and_b32 s56, s56, 4
  s_add_u32 s61, s61, s56
  s_lshl_b32 s61, s61, 2
  s_add_u32 s62, s62, s61
  s_lshl_b32 s61, s53, 10
  s_add_u32 s62, s62, s61
  s_add_u32 s62, s62, 12582912
  s_mul_i32 s62, s52, 12288
  s_lshl_b32 s61, s55, 7
  s_add_u32 s62, s62, s61
  s_add_u32 s62, s62, 12582912
  s_lshl_b32 s61, s3, 2
  s_add_u32 s62, s62, s61
  s_xor_b32 s56, s52, 0
  s_lshl_b32 s57, s56, 3
  s_add_u32 s57, s57, s54
  s_lshl_b32 s57, s57, 2
  s_add_u32 s57, s57, s3
  s_lshl_b32 s57, s57, 15
  s_add_u32 s4, s57, 4194304
  s_mul_i32 s56, s56, 12288
  s_lshl_b32 s57, s3, 3
  s_add_u32 s57, s57, s54
  s_lshl_b32 s57, s57, 7
  s_add_u32 s57, s57, s56
  s_add_u32 s5, s57, 12587008
  s_xor_b32 s56, s52, 4
  s_lshl_b32 s57, s56, 3
  s_add_u32 s57, s57, s54
  s_lshl_b32 s57, s57, 2
  s_add_u32 s57, s57, s3
  s_lshl_b32 s57, s57, 15
  s_add_u32 s6, s57, 4194304
  s_mul_i32 s56, s56, 12288
  s_lshl_b32 s57, s3, 3
  s_add_u32 s57, s57, s54
  s_lshl_b32 s57, s57, 7
  s_add_u32 s57, s57, s56
  s_add_u32 s7, s57, 12587008
  s_lshl_b32 s56, s53, 12
  s_add_u32 s4, s4, s56
  s_lshl_b32 s56, s53, 2
  s_add_u32 s5, s5, s56
  s_add_u32 s11, s7, 4096
  s_sub_u32 s56, s53, s3
  s_sub_u32 s56, s56, 1
  s_and_b32 s56, s56, 3
  s_lshl_b32 s56, s56, 2
  s_add_u32 s9, s11, s56
  s_lshl_b32 s56, s56, 10
  s_add_u32 s8, s6, s56
  s_add_u32 s8, s8, 16384
  s_lshl_b32 s61, s3, 2
  s_add_u32 m0, s61, 161280
  v_add_u32 v12, 0, v6
  v_add_u32 v13, 0, v7
  v_add_u32 v14, 0, v8
  v_add_u32 v15, 0, v9
  v_add_u32 v16, 0, v10
  v_add_u32 v17, 0, v11
  s_waitcnt lgkmcnt(0)
  s_barrier
  ds_read_b64_tr_b16 v[60:61], v12 offset:0
  ds_read_b64_tr_b16 v[62:63], v12 offset:1024
  ds_read_b128 v[68:71], v14 offset:32768
  ds_read_b64_tr_b16 v[80:81], v12 offset:8192
  ds_read_b64_tr_b16 v[82:83], v12 offset:9216
  ds_read_b128 v[88:91], v15 offset:32768
  ds_read_b128 v[72:75], v14 offset:36864
  ds_read_b128 v[92:95], v15 offset:36864
  ds_read_b128 v[76:79], v14 offset:40960
  ds_read_b128 v[96:99], v15 offset:40960
  ds_read_b64_tr_b16 v[64:65], v13 offset:0
  ds_read_b64_tr_b16 v[66:67], v13 offset:1024
  ds_read_b64_tr_b16 v[84:85], v13 offset:8192
  s_waitcnt lgkmcnt(10)
  v_mfma_f32_16x16x32_bf16 v[36:39], v[60:63], v[68:71], 0
  ds_read_b64_tr_b16 v[86:87], v13 offset:9216
  ds_read_b64_tr_b16 v[100:101], v12 offset:16384
  s_waitcnt lgkmcnt(9)
  v_mfma_f32_16x16x32_bf16 v[36:39], v[80:83], v[88:91], v[36:39]
  ds_read_b64_tr_b16 v[102:103], v12 offset:17408
  s_waitcnt lgkmcnt(9)
  v_mfma_f32_16x16x32_bf16 v[44:47], v[60:63], v[72:75], 0
  ds_read_b128 v[108:111], v16 offset:32768
  s_waitcnt lgkmcnt(9)
  v_mfma_f32_16x16x32_bf16 v[44:47], v[80:83], v[92:95], v[44:47]
  ds_read_b64_tr_b16 v[120:121], v12 offset:24576
  ds_read_b64_tr_b16 v[122:123], v12 offset:25600
  ds_read_b128 v[128:131], v17 offset:32768
  v_add_u32 v12, 45056, v6
  s_waitcnt lgkmcnt(11)
  v_mfma_f32_16x16x32_bf16 v[52:55], v[60:63], v[76:79], 0
  ds_read_b128 v[112:115], v16 offset:36864
  s_waitcnt lgkmcnt(11)
  v_mfma_f32_16x16x32_bf16 v[52:55], v[80:83], v[96:99], v[52:55]
  ds_read_b128 v[132:135], v17 offset:36864
  s_waitcnt lgkmcnt(10)
  v_mfma_f32_16x16x32_bf16 v[40:43], v[64:67], v[68:71], 0
  ds_read_b128 v[116:119], v16 offset:40960
  s_waitcnt lgkmcnt(9)
  v_mfma_f32_16x16x32_bf16 v[40:43], v[84:87], v[88:91], v[40:43]
  ds_read_b128 v[136:139], v17 offset:40960
  v_mfma_f32_16x16x32_bf16 v[48:51], v[64:67], v[72:75], 0
  ds_read_b64_tr_b16 v[104:105], v13 offset:16384
  ds_read_b64_tr_b16 v[106:107], v13 offset:17408
  v_mfma_f32_16x16x32_bf16 v[48:51], v[84:87], v[92:95], v[48:51]
  ds_read_b64_tr_b16 v[124:125], v13 offset:24576
  ds_read_b64_tr_b16 v[126:127], v13 offset:25600
  v_add_u32 v13, 45056, v7
  v_mfma_f32_16x16x32_bf16 v[56:59], v[64:67], v[76:79], 0
  v_add_u32 v14, 45056, v8
  v_add_u32 v15, 45056, v9
  v_mfma_f32_16x16x32_bf16 v[56:59], v[84:87], v[96:99], v[56:59]
  s_waitcnt lgkmcnt(11)
  v_add_u32 v16, 45056, v10
  v_add_u32 v17, 45056, v11
  v_mfma_f32_16x16x32_bf16 v[36:39], v[100:103], v[108:111], v[36:39]
  s_waitcnt lgkmcnt(8)
  v_mfma_f32_16x16x32_bf16 v[36:39], v[120:123], v[128:131], v[36:39]
  s_waitcnt lgkmcnt(7)
  v_mfma_f32_16x16x32_bf16 v[44:47], v[100:103], v[112:115], v[44:47]
  s_waitcnt lgkmcnt(6)
  v_mfma_f32_16x16x32_bf16 v[44:47], v[120:123], v[132:135], v[44:47]
  s_waitcnt lgkmcnt(5)
  v_mfma_f32_16x16x32_bf16 v[52:55], v[100:103], v[116:119], v[52:55]
  s_waitcnt lgkmcnt(4)
  v_mfma_f32_16x16x32_bf16 v[52:55], v[120:123], v[136:139], v[52:55]
  s_waitcnt lgkmcnt(2)
  v_mfma_f32_16x16x32_bf16 v[40:43], v[104:107], v[108:111], v[40:43]
  s_waitcnt lgkmcnt(0)
  v_mfma_f32_16x16x32_bf16 v[40:43], v[124:127], v[128:131], v[40:43]
  v_mfma_f32_16x16x32_bf16 v[48:51], v[104:107], v[112:115], v[48:51]
  v_mfma_f32_16x16x32_bf16 v[48:51], v[124:127], v[132:135], v[48:51]
  v_mfma_f32_16x16x32_bf16 v[56:59], v[104:107], v[116:119], v[56:59]
  v_mfma_f32_16x16x32_bf16 v[56:59], v[124:127], v[136:139], v[56:59]
  s_waitcnt lgkmcnt(0)
  s_barrier
  ds_read_b64_tr_b16 v[60:61], v12 offset:0
  ds_read_b64_tr_b16 v[62:63], v12 offset:1024
  ds_read_b128 v[68:71], v14 offset:32768
  ds_read_b64_tr_b16 v[80:81], v12 offset:8192
  ds_read_b64_tr_b16 v[82:83], v12 offset:9216
  ds_read_b128 v[88:91], v15 offset:32768
  ds_read_b128 v[72:75], v14 offset:36864
  ds_read_b128 v[92:95], v15 offset:36864
  ds_read_b128 v[76:79], v14 offset:40960
  ds_read_b128 v[96:99], v15 offset:40960
  ds_read_b64_tr_b16 v[64:65], v13 offset:0
  ds_read_b64_tr_b16 v[66:67], v13 offset:1024
  ds_read_b64_tr_b16 v[84:85], v13 offset:8192
  s_waitcnt lgkmcnt(10)
  v_mfma_f32_16x16x32_bf16 v[36:39], v[60:63], v[68:71], v[36:39]
  ds_read_b64_tr_b16 v[86:87], v13 offset:9216
  ds_read_b64_tr_b16 v[100:101], v12 offset:16384
  s_waitcnt lgkmcnt(9)
  v_mfma_f32_16x16x32_bf16 v[36:39], v[80:83], v[88:91], v[36:39]
  ds_read_b64_tr_b16 v[102:103], v12 offset:17408
  s_waitcnt lgkmcnt(9)
  v_mfma_f32_16x16x32_bf16 v[44:47], v[60:63], v[72:75], v[44:47]
  ds_read_b128 v[108:111], v16 offset:32768
  s_waitcnt lgkmcnt(9)
  v_mfma_f32_16x16x32_bf16 v[44:47], v[80:83], v[92:95], v[44:47]
  ds_read_b64_tr_b16 v[120:121], v12 offset:24576
  ds_read_b64_tr_b16 v[122:123], v12 offset:25600
  ds_read_b128 v[128:131], v17 offset:32768
  v_add_u32 v12, 90112, v6
  s_waitcnt lgkmcnt(11)
  v_mfma_f32_16x16x32_bf16 v[52:55], v[60:63], v[76:79], v[52:55]
  ds_read_b128 v[112:115], v16 offset:36864
  s_waitcnt lgkmcnt(11)
  v_mfma_f32_16x16x32_bf16 v[52:55], v[80:83], v[96:99], v[52:55]
  ds_read_b128 v[132:135], v17 offset:36864
  s_waitcnt lgkmcnt(10)
  v_mfma_f32_16x16x32_bf16 v[40:43], v[64:67], v[68:71], v[40:43]
  ds_read_b128 v[116:119], v16 offset:40960
  s_waitcnt lgkmcnt(9)
  v_mfma_f32_16x16x32_bf16 v[40:43], v[84:87], v[88:91], v[40:43]
  ds_read_b128 v[136:139], v17 offset:40960
  v_mfma_f32_16x16x32_bf16 v[48:51], v[64:67], v[72:75], v[48:51]
  ds_read_b64_tr_b16 v[104:105], v13 offset:16384
  ds_read_b64_tr_b16 v[106:107], v13 offset:17408
  v_mfma_f32_16x16x32_bf16 v[48:51], v[84:87], v[92:95], v[48:51]
  ds_read_b64_tr_b16 v[124:125], v13 offset:24576
  ds_read_b64_tr_b16 v[126:127], v13 offset:25600
  v_add_u32 v13, 90112, v7
  v_mfma_f32_16x16x32_bf16 v[56:59], v[64:67], v[76:79], v[56:59]
  v_add_u32 v14, 90112, v8
  v_add_u32 v15, 90112, v9
  v_mfma_f32_16x16x32_bf16 v[56:59], v[84:87], v[96:99], v[56:59]
  s_waitcnt lgkmcnt(11)
  v_add_u32 v16, 90112, v10
  v_add_u32 v17, 90112, v11
  v_mfma_f32_16x16x32_bf16 v[36:39], v[100:103], v[108:111], v[36:39]
  s_waitcnt lgkmcnt(8)
  v_mfma_f32_16x16x32_bf16 v[36:39], v[120:123], v[128:131], v[36:39]
  s_waitcnt lgkmcnt(7)
  v_mfma_f32_16x16x32_bf16 v[44:47], v[100:103], v[112:115], v[44:47]
  s_waitcnt lgkmcnt(6)
  v_mfma_f32_16x16x32_bf16 v[44:47], v[120:123], v[132:135], v[44:47]
  s_waitcnt lgkmcnt(5)
  v_mfma_f32_16x16x32_bf16 v[52:55], v[100:103], v[116:119], v[52:55]
  s_waitcnt lgkmcnt(4)
  v_mfma_f32_16x16x32_bf16 v[52:55], v[120:123], v[136:139], v[52:55]
  s_waitcnt lgkmcnt(2)
  v_mfma_f32_16x16x32_bf16 v[40:43], v[104:107], v[108:111], v[40:43]
  s_waitcnt lgkmcnt(0)
  v_mfma_f32_16x16x32_bf16 v[40:43], v[124:127], v[128:131], v[40:43]
  v_mfma_f32_16x16x32_bf16 v[48:51], v[104:107], v[112:115], v[48:51]
  v_mfma_f32_16x16x32_bf16 v[48:51], v[124:127], v[132:135], v[48:51]
  v_mfma_f32_16x16x32_bf16 v[56:59], v[104:107], v[116:119], v[56:59]
  v_mfma_f32_16x16x32_bf16 v[56:59], v[124:127], v[136:139], v[56:59]
  s_waitcnt lgkmcnt(0)
  s_barrier
  ds_read_b64_tr_b16 v[60:61], v12 offset:0
  ds_read_b64_tr_b16 v[62:63], v12 offset:1024
  ds_read_b128 v[68:71], v14 offset:32768
  ds_read_b64_tr_b16 v[80:81], v12 offset:8192
  ds_read_b64_tr_b16 v[82:83], v12 offset:9216
  ds_read_b128 v[88:91], v15 offset:32768
  ds_read_b128 v[72:75], v14 offset:36864
  ds_read_b128 v[92:95], v15 offset:36864
  ds_read_b128 v[76:79], v14 offset:40960
  ds_read_b128 v[96:99], v15 offset:40960
  ds_read_b64_tr_b16 v[64:65], v13 offset:0
  ds_read_b64_tr_b16 v[66:67], v13 offset:1024
  ds_read_b64_tr_b16 v[84:85], v13 offset:8192
  s_waitcnt lgkmcnt(10)
  v_mfma_f32_16x16x32_bf16 v[36:39], v[60:63], v[68:71], v[36:39]
  ds_read_b64_tr_b16 v[86:87], v13 offset:9216
  ds_read_b64_tr_b16 v[100:101], v12 offset:16384
  s_waitcnt lgkmcnt(9)
  v_mfma_f32_16x16x32_bf16 v[36:39], v[80:83], v[88:91], v[36:39]
  ds_read_b64_tr_b16 v[102:103], v12 offset:17408
  s_waitcnt lgkmcnt(9)
  v_mfma_f32_16x16x32_bf16 v[44:47], v[60:63], v[72:75], v[44:47]
  ds_read_b128 v[108:111], v16 offset:32768
  s_waitcnt lgkmcnt(9)
  v_mfma_f32_16x16x32_bf16 v[44:47], v[80:83], v[92:95], v[44:47]
  ds_read_b64_tr_b16 v[120:121], v12 offset:24576
  ds_read_b64_tr_b16 v[122:123], v12 offset:25600
  ds_read_b128 v[128:131], v17 offset:32768
  v_add_u32 v12, 0, v6
  s_waitcnt lgkmcnt(11)
  v_mfma_f32_16x16x32_bf16 v[52:55], v[60:63], v[76:79], v[52:55]
  ds_read_b128 v[112:115], v16 offset:36864
  s_waitcnt lgkmcnt(11)
  v_mfma_f32_16x16x32_bf16 v[52:55], v[80:83], v[96:99], v[52:55]
  ds_read_b128 v[132:135], v17 offset:36864
  s_waitcnt lgkmcnt(10)
  v_mfma_f32_16x16x32_bf16 v[40:43], v[64:67], v[68:71], v[40:43]
  ds_read_b128 v[116:119], v16 offset:40960
  s_waitcnt lgkmcnt(9)
  v_mfma_f32_16x16x32_bf16 v[40:43], v[84:87], v[88:91], v[40:43]
  ds_read_b128 v[136:139], v17 offset:40960
  v_mfma_f32_16x16x32_bf16 v[48:51], v[64:67], v[72:75], v[48:51]
  ds_read_b64_tr_b16 v[104:105], v13 offset:16384
  ds_read_b64_tr_b16 v[106:107], v13 offset:17408
  v_mfma_f32_16x16x32_bf16 v[48:51], v[84:87], v[92:95], v[48:51]
  ds_read_b64_tr_b16 v[124:125], v13 offset:24576
  ds_read_b64_tr_b16 v[126:127], v13 offset:25600
  v_add_u32 v13, 0, v7
  v_mfma_f32_16x16x32_bf16 v[56:59], v[64:67], v[76:79], v[56:59]
  v_add_u32 v14, 0, v8
  v_add_u32 v15, 0, v9
  v_mfma_f32_16x16x32_bf16 v[56:59], v[84:87], v[96:99], v[56:59]
  s_waitcnt lgkmcnt(11)
  v_add_u32 v16, 0, v10
  v_add_u32 v17, 0, v11
  v_mfma_f32_16x16x32_bf16 v[36:39], v[100:103], v[108:111], v[36:39]
  s_waitcnt lgkmcnt(8)
  v_mfma_f32_16x16x32_bf16 v[36:39], v[120:123], v[128:131], v[36:39]
  s_waitcnt lgkmcnt(7)
  v_mfma_f32_16x16x32_bf16 v[44:47], v[100:103], v[112:115], v[44:47]
  s_waitcnt lgkmcnt(6)
  v_mfma_f32_16x16x32_bf16 v[44:47], v[120:123], v[132:135], v[44:47]
  s_waitcnt lgkmcnt(5)
  v_mfma_f32_16x16x32_bf16 v[52:55], v[100:103], v[116:119], v[52:55]
  s_waitcnt lgkmcnt(4)
  v_mfma_f32_16x16x32_bf16 v[52:55], v[120:123], v[136:139], v[52:55]
  s_waitcnt lgkmcnt(2)
  v_mfma_f32_16x16x32_bf16 v[40:43], v[104:107], v[108:111], v[40:43]
  s_waitcnt lgkmcnt(0)
  v_mfma_f32_16x16x32_bf16 v[40:43], v[124:127], v[128:131], v[40:43]
  v_mfma_f32_16x16x32_bf16 v[48:51], v[104:107], v[112:115], v[48:51]
  v_mfma_f32_16x16x32_bf16 v[48:51], v[124:127], v[132:135], v[48:51]
  v_mfma_f32_16x16x32_bf16 v[56:59], v[104:107], v[116:119], v[56:59]
  v_mfma_f32_16x16x32_bf16 v[56:59], v[124:127], v[136:139], v[56:59]
  s_waitcnt lgkmcnt(0)
  s_barrier
  s_cmp_lg_u32 s28, 0
  s_cbranch_scc1 L_nolead2
  s_waitcnt vmcnt(0)
  s_mov_b64 exec, 1
  buffer_store_dword v4, v5, s[48:51], s29 offen sc1
  s_mov_b64 exec, -1
L_nolead2:
  ds_read_b64_tr_b16 v[60:61], v12 offset:0
  ds_read_b64_tr_b16 v[62:63], v12 offset:1024
  ds_read_b128 v[68:71], v14 offset:32768
  ds_read_b64_tr_b16 v[80:81], v12 offset:8192
  ds_read_b64_tr_b16 v[82:83], v12 offset:9216
  ds_read_b128 v[88:91], v15 offset:32768
  ds_read_b128 v[72:75], v14 offset:36864
  ds_read_b128 v[92:95], v15 offset:36864
  ds_read_b128 v[76:79], v14 offset:40960
  ds_read_b128 v[96:99], v15 offset:40960
  ds_read_b64_tr_b16 v[64:65], v13 offset:0
  ds_read_b64_tr_b16 v[66:67], v13 offset:1024
  ds_read_b64_tr_b16 v[84:85], v13 offset:8192
  s_waitcnt lgkmcnt(10)
  v_mfma_f32_16x16x32_bf16 v[36:39], v[60:63], v[68:71], v[36:39]
  ds_read_b64_tr_b16 v[86:87], v13 offset:9216
  ds_read_b64_tr_b16 v[100:101], v12 offset:16384
  s_waitcnt lgkmcnt(9)
  v_mfma_f32_16x16x32_bf16 v[36:39], v[80:83], v[88:91], v[36:39]
  ds_read_b64_tr_b16 v[102:103], v12 offset:17408
  s_waitcnt lgkmcnt(9)
  v_mfma_f32_16x16x32_bf16 v[44:47], v[60:63], v[72:75], v[44:47]
  ds_read_b128 v[108:111], v16 offset:32768
  s_waitcnt lgkmcnt(9)
  v_mfma_f32_16x16x32_bf16 v[44:47], v[80:83], v[92:95], v[44:47]
  ds_read_b64_tr_b16 v[120:121], v12 offset:24576
  ds_read_b64_tr_b16 v[122:123], v12 offset:25600
  ds_read_b128 v[128:131], v17 offset:32768
  v_add_u32 v12, 45056, v6
  s_waitcnt lgkmcnt(11)
  v_mfma_f32_16x16x32_bf16 v[52:55], v[60:63], v[76:79], v[52:55]
  ds_read_b128 v[112:115], v16 offset:36864
  s_waitcnt lgkmcnt(11)
  v_mfma_f32_16x16x32_bf16 v[52:55], v[80:83], v[96:99], v[52:55]
  ds_read_b128 v[132:135], v17 offset:36864
  s_waitcnt lgkmcnt(10)
  v_mfma_f32_16x16x32_bf16 v[40:43], v[64:67], v[68:71], v[40:43]
  ds_read_b128 v[116:119], v16 offset:40960
  s_waitcnt lgkmcnt(9)
  v_mfma_f32_16x16x32_bf16 v[40:43], v[84:87], v[88:91], v[40:43]
  ds_read_b128 v[136:139], v17 offset:40960
  v_mfma_f32_16x16x32_bf16 v[48:51], v[64:67], v[72:75], v[48:51]
  ds_read_b64_tr_b16 v[104:105], v13 offset:16384
  ds_read_b64_tr_b16 v[106:107], v13 offset:17408
  v_mfma_f32_16x16x32_bf16 v[48:51], v[84:87], v[92:95], v[48:51]
  ds_read_b64_tr_b16 v[124:125], v13 offset:24576
  ds_read_b64_tr_b16 v[126:127], v13 offset:25600
  v_add_u32 v13, 45056, v7
  v_mfma_f32_16x16x32_bf16 v[56:59], v[64:67], v[76:79], v[56:59]
  v_add_u32 v14, 45056, v8
  v_add_u32 v15, 45056, v9
  v_mfma_f32_16x16x32_bf16 v[56:59], v[84:87], v[96:99], v[56:59]
  s_waitcnt lgkmcnt(11)
  v_add_u32 v16, 45056, v10
  v_add_u32 v17, 45056, v11
  v_mfma_f32_16x16x32_bf16 v[36:39], v[100:103], v[108:111], v[36:39]
  s_waitcnt lgkmcnt(8)
  v_mfma_f32_16x16x32_bf16 v[36:39], v[120:123], v[128:131], v[36:39]
  s_waitcnt lgkmcnt(7)
  v_mfma_f32_16x16x32_bf16 v[44:47], v[100:103], v[112:115], v[44:47]
  s_waitcnt lgkmcnt(6)
  v_mfma_f32_16x16x32_bf16 v[44:47], v[120:123], v[132:135], v[44:47]
  s_waitcnt lgkmcnt(5)
  v_mfma_f32_16x16x32_bf16 v[52:55], v[100:103], v[116:119], v[52:55]
  s_waitcnt lgkmcnt(4)
  v_mfma_f32_16x16x32_bf16 v[52:55], v[120:123], v[136:139], v[52:55]
  s_waitcnt lgkmcnt(2)
  v_mfma_f32_16x16x32_bf16 v[40:43], v[104:107], v[108:111], v[40:43]
  s_waitcnt lgkmcnt(0)
  v_mfma_f32_16x16x32_bf16 v[40:43], v[124:127], v[128:131], v[40:43]
  v_mfma_f32_16x16x32_bf16 v[48:51], v[104:107], v[112:115], v[48:51]
  v_mfma_f32_16x16x32_bf16 v[48:51], v[124:127], v[132:135], v[48:51]
  v_mfma_f32_16x16x32_bf16 v[56:59], v[104:107], v[116:119], v[56:59]
  v_mfma_f32_16x16x32_bf16 v[56:59], v[124:127], v[136:139], v[56:59]
  s_cmp_lg_u32 s3, 0
  s_cbranch_scc1 L_norf4
  s_mov_b64 exec, 511
  global_load_dword v159, v[154:155], off
  s_mov_b64 exec, -1
L_norf4:
  s_waitcnt lgkmcnt(0)
  s_barrier
  ds_read_b64_tr_b16 v[60:61], v12 offset:0
  ds_read_b64_tr_b16 v[62:63], v12 offset:1024
  ds_read_b128 v[68:71], v14 offset:32768
  ds_read_b64_tr_b16 v[80:81], v12 offset:8192
  ds_read_b64_tr_b16 v[82:83], v12 offset:9216
  ds_read_b128 v[88:91], v15 offset:32768
  ds_read_b128 v[72:75], v14 offset:36864
  ds_read_b128 v[92:95], v15 offset:36864
  ds_read_b128 v[76:79], v14 offset:40960
  ds_read_b128 v[96:99], v15 offset:40960
  ds_read_b64_tr_b16 v[64:65], v13 offset:0
  ds_read_b64_tr_b16 v[66:67], v13 offset:1024
  ds_read_b64_tr_b16 v[84:85], v13 offset:8192
  s_waitcnt lgkmcnt(10)
  v_mfma_f32_16x16x32_bf16 v[36:39], v[60:63], v[68:71], v[36:39]
  ds_read_b64_tr_b16 v[86:87], v13 offset:9216
  ds_read_b64_tr_b16 v[100:101], v12 offset:16384
  s_waitcnt lgkmcnt(9)
  v_mfma_f32_16x16x32_bf16 v[36:39], v[80:83], v[88:91], v[36:39]
  ds_read_b64_tr_b16 v[102:103], v12 offset:17408
  s_waitcnt lgkmcnt(9)
  v_mfma_f32_16x16x32_bf16 v[44:47], v[60:63], v[72:75], v[44:47]
  ds_read_b128 v[108:111], v16 offset:32768
  s_waitcnt lgkmcnt(9)
  v_mfma_f32_16x16x32_bf16 v[44:47], v[80:83], v[92:95], v[44:47]
  ds_read_b64_tr_b16 v[120:121], v12 offset:24576
  ds_read_b64_tr_b16 v[122:123], v12 offset:25600
  ds_read_b128 v[128:131], v17 offset:32768
  v_add_u32 v12, 90112, v6
  s_waitcnt lgkmcnt(11)
  v_mfma_f32_16x16x32_bf16 v[52:55], v[60:63], v[76:79], v[52:55]
  ds_read_b128 v[112:115], v16 offset:36864
  s_waitcnt lgkmcnt(11)
  v_mfma_f32_16x16x32_bf16 v[52:55], v[80:83], v[96:99], v[52:55]
  ds_read_b128 v[132:135], v17 offset:36864
  s_waitcnt lgkmcnt(10)
  v_mfma_f32_16x16x32_bf16 v[40:43], v[64:67], v[68:71], v[40:43]
  ds_read_b128 v[116:119], v16 offset:40960
  s_waitcnt lgkmcnt(9)
  v_mfma_f32_16x16x32_bf16 v[40:43], v[84:87], v[88:91], v[40:43]
  ds_read_b128 v[136:139], v17 offset:40960
  v_mfma_f32_16x16x32_bf16 v[48:51], v[64:67], v[72:75], v[48:51]
  ds_read_b64_tr_b16 v[104:105], v13 offset:16384
  ds_read_b64_tr_b16 v[106:107], v13 offset:17408
  v_mfma_f32_16x16x32_bf16 v[48:51], v[84:87], v[92:95], v[48:51]
  ds_read_b64_tr_b16 v[124:125], v13 offset:24576
  ds_read_b64_tr_b16 v[126:127], v13 offset:25600
  v_add_u32 v13, 90112, v7
  v_mfma_f32_16x16x32_bf16 v[56:59], v[64:67], v[76:79], v[56:59]
  v_add_u32 v14, 90112, v8
  v_add_u32 v15, 90112, v9
  v_mfma_f32_16x16x32_bf16 v[56:59], v[84:87], v[96:99], v[56:59]
  s_waitcnt lgkmcnt(11)
  v_add_u32 v16, 90112, v10
  v_add_u32 v17, 90112, v11
  v_mfma_f32_16x16x32_bf16 v[36:39], v[100:103], v[108:111], v[36:39]
  s_waitcnt lgkmcnt(8)
  v_mfma_f32_16x16x32_bf16 v[36:39], v[120:123], v[128:131], v[36:39]
  s_waitcnt lgkmcnt(7)
  v_mfma_f32_16x16x32_bf16 v[44:47], v[100:103], v[112:115], v[44:47]
  s_waitcnt lgkmcnt(6)
  v_mfma_f32_16x16x32_bf16 v[44:47], v[120:123], v[132:135], v[44:47]
  s_waitcnt lgkmcnt(5)
  v_mfma_f32_16x16x32_bf16 v[52:55], v[100:103], v[116:119], v[52:55]
  s_waitcnt lgkmcnt(4)
  v_mfma_f32_16x16x32_bf16 v[52:55], v[120:123], v[136:139], v[52:55]
  s_waitcnt lgkmcnt(2)
  v_mfma_f32_16x16x32_bf16 v[40:43], v[104:107], v[108:111], v[40:43]
  s_waitcnt lgkmcnt(0)
  v_mfma_f32_16x16x32_bf16 v[40:43], v[124:127], v[128:131], v[40:43]
  v_mfma_f32_16x16x32_bf16 v[48:51], v[104:107], v[112:115], v[48:51]
  v_mfma_f32_16x16x32_bf16 v[48:51], v[124:127], v[132:135], v[48:51]
  v_mfma_f32_16x16x32_bf16 v[56:59], v[104:107], v[116:119], v[56:59]
  v_mfma_f32_16x16x32_bf16 v[56:59], v[124:127], v[136:139], v[56:59]
  s_waitcnt lgkmcnt(0)
  s_barrier
  ds_read_b64_tr_b16 v[60:61], v12 offset:0
  ds_read_b64_tr_b16 v[62:63], v12 offset:1024
  ds_read_b128 v[68:71], v14 offset:32768
  ds_read_b64_tr_b16 v[80:81], v12 offset:8192
  ds_read_b64_tr_b16 v[82:83], v12 offset:9216
  ds_read_b128 v[88:91], v15 offset:32768
  ds_read_b128 v[72:75], v14 offset:36864
  ds_read_b128 v[92:95], v15 offset:36864
  ds_read_b128 v[76:79], v14 offset:40960
  ds_read_b128 v[96:99], v15 offset:40960
  ds_read_b64_tr_b16 v[64:65], v13 offset:0
  ds_read_b64_tr_b16 v[66:67], v13 offset:1024
  ds_read_b64_tr_b16 v[84:85], v13 offset:8192
  s_waitcnt lgkmcnt(10)
  v_mfma_f32_16x16x32_bf16 v[36:39], v[60:63], v[68:71], v[36:39]
  ds_read_b64_tr_b16 v[86:87], v13 offset:9216
  ds_read_b64_tr_b16 v[100:101], v12 offset:16384
  s_waitcnt lgkmcnt(9)
  v_mfma_f32_16x16x32_bf16 v[36:39], v[80:83], v[88:91], v[36:39]
  ds_read_b64_tr_b16 v[102:103], v12 offset:17408
  s_waitcnt lgkmcnt(9)
  v_mfma_f32_16x16x32_bf16 v[44:47], v[60:63], v[72:75], v[44:47]
  ds_read_b128 v[108:111], v16 offset:32768
  s_waitcnt lgkmcnt(9)
  v_mfma_f32_16x16x32_bf16 v[44:47], v[80:83], v[92:95], v[44:47]
  ds_read_b64_tr_b16 v[120:121], v12 offset:24576
  ds_read_b64_tr_b16 v[122:123], v12 offset:25600
  ds_read_b128 v[128:131], v17 offset:32768
  v_add_u32 v12, 0, v6
  s_waitcnt lgkmcnt(11)
  v_mfma_f32_16x16x32_bf16 v[52:55], v[60:63], v[76:79], v[52:55]
  ds_read_b128 v[112:115], v16 offset:36864
  s_waitcnt lgkmcnt(11)
  v_mfma_f32_16x16x32_bf16 v[52:55], v[80:83], v[96:99], v[52:55]
  ds_read_b128 v[132:135], v17 offset:36864
  s_waitcnt lgkmcnt(10)
  v_mfma_f32_16x16x32_bf16 v[40:43], v[64:67], v[68:71], v[40:43]
  ds_read_b128 v[116:119], v16 offset:40960
  s_waitcnt lgkmcnt(9)
  v_mfma_f32_16x16x32_bf16 v[40:43], v[84:87], v[88:91], v[40:43]
  ds_read_b128 v[136:139], v17 offset:40960
  v_mfma_f32_16x16x32_bf16 v[48:51], v[64:67], v[72:75], v[48:51]
  ds_read_b64_tr_b16 v[104:105], v13 offset:16384
  ds_read_b64_tr_b16 v[106:107], v13 offset:17408
  v_mfma_f32_16x16x32_bf16 v[48:51], v[84:87], v[92:95], v[48:51]
  ds_read_b64_tr_b16 v[124:125], v13 offset:24576
  ds_read_b64_tr_b16 v[126:127], v13 offset:25600
  v_add_u32 v13, 0, v7
  v_mfma_f32_16x16x32_bf16 v[56:59], v[64:67], v[76:79], v[56:59]
  v_add_u32 v14, 0, v8
  v_add_u32 v15, 0, v9
  v_mfma_f32_16x16x32_bf16 v[56:59], v[84:87], v[96:99], v[56:59]
  s_waitcnt lgkmcnt(11)
  v_add_u32 v16, 0, v10
  v_add_u32 v17, 0, v11
  v_mfma_f32_16x16x32_bf16 v[36:39], v[100:103], v[108:111], v[36:39]
  s_waitcnt lgkmcnt(8)
  v_mfma_f32_16x16x32_bf16 v[36:39], v[120:123], v[128:131], v[36:39]
  s_waitcnt lgkmcnt(7)
  v_mfma_f32_16x16x32_bf16 v[44:47], v[100:103], v[112:115], v[44:47]
  s_waitcnt lgkmcnt(6)
  v_mfma_f32_16x16x32_bf16 v[44:47], v[120:123], v[132:135], v[44:47]
  s_waitcnt lgkmcnt(5)
  v_mfma_f32_16x16x32_bf16 v[52:55], v[100:103], v[116:119], v[52:55]
  s_waitcnt lgkmcnt(4)
  v_mfma_f32_16x16x32_bf16 v[52:55], v[120:123], v[136:139], v[52:55]
  s_waitcnt lgkmcnt(2)
  v_mfma_f32_16x16x32_bf16 v[40:43], v[104:107], v[108:111], v[40:43]
  s_waitcnt lgkmcnt(0)
  v_mfma_f32_16x16x32_bf16 v[40:43], v[124:127], v[128:131], v[40:43]
  v_mfma_f32_16x16x32_bf16 v[48:51], v[104:107], v[112:115], v[48:51]
  v_mfma_f32_16x16x32_bf16 v[48:51], v[124:127], v[132:135], v[48:51]
  v_mfma_f32_16x16x32_bf16 v[56:59], v[104:107], v[116:119], v[56:59]
  v_mfma_f32_16x16x32_bf16 v[56:59], v[124:127], v[136:139], v[56:59]
  s_waitcnt lgkmcnt(0)
  s_barrier
  ds_read_b64_tr_b16 v[60:61], v12 offset:0
  ds_read_b64_tr_b16 v[62:63], v12 offset:1024
  ds_read_b128 v[68:71], v14 offset:32768
  ds_read_b64_tr_b16 v[80:81], v12 offset:8192
  ds_read_b64_tr_b16 v[82:83], v12 offset:9216
  ds_read_b128 v[88:91], v15 offset:32768
  ds_read_b128 v[72:75], v14 offset:36864
  ds_read_b128 v[92:95], v15 offset:36864
  ds_read_b128 v[76:79], v14 offset:40960
  ds_read_b128 v[96:99], v15 offset:40960
  ds_read_b64_tr_b16 v[64:65], v13 offset:0
  ds_read_b64_tr_b16 v[66:67], v13 offset:1024
  ds_read_b64_tr_b16 v[84:85], v13 offset:8192
  s_waitcnt lgkmcnt(10)
  v_mfma_f32_16x16x32_bf16 v[36:39], v[60:63], v[68:71], v[36:39]
  ds_read_b64_tr_b16 v[86:87], v13 offset:9216
  ds_read_b64_tr_b16 v[100:101], v12 offset:16384
  s_waitcnt lgkmcnt(9)
  v_mfma_f32_16x16x32_bf16 v[36:39], v[80:83], v[88:91], v[36:39]
  ds_read_b64_tr_b16 v[102:103], v12 offset:17408
  s_waitcnt lgkmcnt(9)
  v_mfma_f32_16x16x32_bf16 v[44:47], v[60:63], v[72:75], v[44:47]
  ds_read_b128 v[108:111], v16 offset:32768
  s_waitcnt lgkmcnt(9)
  v_mfma_f32_16x16x32_bf16 v[44:47], v[80:83], v[92:95], v[44:47]
  ds_read_b64_tr_b16 v[120:121], v12 offset:24576
  ds_read_b64_tr_b16 v[122:123], v12 offset:25600
  ds_read_b128 v[128:131], v17 offset:32768
  v_add_u32 v12, 45056, v6
  s_waitcnt lgkmcnt(11)
  v_mfma_f32_16x16x32_bf16 v[52:55], v[60:63], v[76:79], v[52:55]
  ds_read_b128 v[112:115], v16 offset:36864
  s_waitcnt lgkmcnt(11)
  v_mfma_f32_16x16x32_bf16 v[52:55], v[80:83], v[96:99], v[52:55]
  ds_read_b128 v[132:135], v17 offset:36864
  s_waitcnt lgkmcnt(10)
  v_mfma_f32_16x16x32_bf16 v[40:43], v[64:67], v[68:71], v[40:43]
  ds_read_b128 v[116:119], v16 offset:40960
  s_waitcnt lgkmcnt(9)
  v_mfma_f32_16x16x32_bf16 v[40:43], v[84:87], v[88:91], v[40:43]
  ds_read_b128 v[136:139], v17 offset:40960
  v_mfma_f32_16x16x32_bf16 v[48:51], v[64:67], v[72:75], v[48:51]
  ds_read_b64_tr_b16 v[104:105], v13 offset:16384
  ds_read_b64_tr_b16 v[106:107], v13 offset:17408
  v_mfma_f32_16x16x32_bf16 v[48:51], v[84:87], v[92:95], v[48:51]
  ds_read_b64_tr_b16 v[124:125], v13 offset:24576
  ds_read_b64_tr_b16 v[126:127], v13 offset:25600
  v_add_u32 v13, 45056, v7
  v_mfma_f32_16x16x32_bf16 v[56:59], v[64:67], v[76:79], v[56:59]
  v_add_u32 v14, 45056, v8
  v_add_u32 v15, 45056, v9
  v_mfma_f32_16x16x32_bf16 v[56:59], v[84:87], v[96:99], v[56:59]
  s_waitcnt lgkmcnt(11)
  v_add_u32 v16, 45056, v10
  v_add_u32 v17, 45056, v11
  v_mfma_f32_16x16x32_bf16 v[36:39], v[100:103], v[108:111], v[36:39]
  s_waitcnt lgkmcnt(8)
  v_mfma_f32_16x16x32_bf16 v[36:39], v[120:123], v[128:131], v[36:39]
  s_waitcnt lgkmcnt(7)
  v_mfma_f32_16x16x32_bf16 v[44:47], v[100:103], v[112:115], v[44:47]
  s_waitcnt lgkmcnt(6)
  v_mfma_f32_16x16x32_bf16 v[44:47], v[120:123], v[132:135], v[44:47]
  s_waitcnt lgkmcnt(5)
  v_mfma_f32_16x16x32_bf16 v[52:55], v[100:103], v[116:119], v[52:55]
  s_waitcnt lgkmcnt(4)
  v_mfma_f32_16x16x32_bf16 v[52:55], v[120:123], v[136:139], v[52:55]
  s_waitcnt lgkmcnt(2)
  v_mfma_f32_16x16x32_bf16 v[40:43], v[104:107], v[108:111], v[40:43]
  s_waitcnt lgkmcnt(0)
  v_mfma_f32_16x16x32_bf16 v[40:43], v[124:127], v[128:131], v[40:43]
  v_mfma_f32_16x16x32_bf16 v[48:51], v[104:107], v[112:115], v[48:51]
  v_mfma_f32_16x16x32_bf16 v[48:51], v[124:127], v[132:135], v[48:51]
  v_mfma_f32_16x16x32_bf16 v[56:59], v[104:107], v[116:119], v[56:59]
  v_mfma_f32_16x16x32_bf16 v[56:59], v[124:127], v[136:139], v[56:59]
  s_cmp_lg_u32 s3, 0
  s_cbranch_scc1 L_norf7
  s_mov_b64 exec, 511
  s_waitcnt vmcnt(0)
  global_load_dword v159, v[154:155], off
  s_mov_b64 exec, -1
L_norf7:
  s_waitcnt lgkmcnt(0)
  s_barrier
  ds_read_b64_tr_b16 v[60:61], v12 offset:0
  ds_read_b64_tr_b16 v[62:63], v12 offset:1024
  ds_read_b128 v[68:71], v14 offset:32768
  ds_read_b128 v[72:75], v14 offset:36864
  ds_read_b128 v[76:79], v14 offset:40960
  ds_read_b64_tr_b16 v[64:65], v13 offset:0
  ds_read_b64_tr_b16 v[66:67], v13 offset:1024
  ds_read_b64_tr_b16 v[80:81], v12 offset:8192
  ds_read_b64_tr_b16 v[82:83], v12 offset:9216
  v_add_u32 v14, 0x10000, v8
  ds_read_b128 v[88:91], v15 offset:32768
  ds_read_b128 v[92:95], v15 offset:36864
  ds_read_b128 v[96:99], v15 offset:40960
  v_add_u32 v15, 0x10000, v9
  ds_read_b64_tr_b16 v[84:85], v13 offset:8192
  ds_read_b64_tr_b16 v[86:87], v13 offset:9216
  s_waitcnt lgkmcnt(11)
  v_mfma_f32_16x16x32_bf16 v[36:39], v[60:63], v[68:71], v[36:39]
  ds_read_b64_tr_b16 v[100:101], v12 offset:16384
  s_waitcnt lgkmcnt(11)
  v_mfma_f32_16x16x32_bf16 v[44:47], v[60:63], v[72:75], v[44:47]
  ds_read_b64_tr_b16 v[102:103], v12 offset:17408
  s_waitcnt lgkmcnt(11)
  v_mfma_f32_16x16x32_bf16 v[52:55], v[60:63], v[76:79], v[52:55]
  ds_read_b128 v[108:111], v16 offset:32768
  s_waitcnt lgkmcnt(10)
  v_mfma_f32_16x16x32_bf16 v[40:43], v[64:67], v[68:71], v[40:43]
  ds_read_b128 v[112:115], v16 offset:36864
  v_mfma_f32_16x16x32_bf16 v[48:51], v[64:67], v[72:75], v[48:51]
  ds_read_b128 v[116:119], v16 offset:40960
  v_add_u32 v16, 0x10000, v10
  v_mfma_f32_16x16x32_bf16 v[56:59], v[64:67], v[76:79], v[56:59]
  ds_read_b64_tr_b16 v[104:105], v13 offset:16384
  ds_read_b64_tr_b16 v[106:107], v13 offset:17408
  s_waitcnt lgkmcnt(11)
  v_mfma_f32_16x16x32_bf16 v[36:39], v[80:83], v[88:91], v[36:39]
  ds_read_b64_tr_b16 v[120:121], v12 offset:24576
  s_waitcnt lgkmcnt(11)
  v_mfma_f32_16x16x32_bf16 v[44:47], v[80:83], v[92:95], v[44:47]
  ds_read_b64_tr_b16 v[122:123], v12 offset:25600
  s_waitcnt lgkmcnt(11)
  v_mfma_f32_16x16x32_bf16 v[52:55], v[80:83], v[96:99], v[52:55]
  ds_read_b128 v[128:131], v17 offset:32768
  s_waitcnt lgkmcnt(10)
  v_mfma_f32_16x16x32_bf16 v[40:43], v[84:87], v[88:91], v[40:43]
  ds_read_b128 v[132:135], v17 offset:36864
  v_mfma_f32_16x16x32_bf16 v[48:51], v[84:87], v[92:95], v[48:51]
  ds_read_b128 v[136:139], v17 offset:40960
  v_add_u32 v17, 0x10000, v11
  v_mfma_f32_16x16x32_bf16 v[56:59], v[84:87], v[96:99], v[56:59]
  ds_read_b64_tr_b16 v[124:125], v13 offset:24576
  ds_read_b64_tr_b16 v[126:127], v13 offset:25600
  s_waitcnt lgkmcnt(11)
  v_mfma_f32_16x16x32_bf16 v[36:39], v[100:103], v[108:111], v[36:39]
  s_waitcnt lgkmcnt(10)
  v_mfma_f32_16x16x32_bf16 v[44:47], v[100:103], v[112:115], v[44:47]
  s_waitcnt lgkmcnt(9)
  v_mfma_f32_16x16x32_bf16 v[52:55], v[100:103], v[116:119], v[52:55]
  s_waitcnt lgkmcnt(7)
  v_mfma_f32_16x16x32_bf16 v[40:43], v[104:107], v[108:111], v[40:43]
  v_mfma_f32_16x16x32_bf16 v[48:51], v[104:107], v[112:115], v[48:51]
  v_mfma_f32_16x16x32_bf16 v[56:59], v[104:107], v[116:119], v[56:59]
  s_waitcnt lgkmcnt(4)
  v_mfma_f32_16x16x32_bf16 v[36:39], v[120:123], v[128:131], v[36:39]
  s_waitcnt lgkmcnt(3)
  v_mfma_f32_16x16x32_bf16 v[44:47], v[120:123], v[132:135], v[44:47]
  s_waitcnt lgkmcnt(2)
  v_mfma_f32_16x16x32_bf16 v[52:55], v[120:123], v[136:139], v[52:55]
  s_waitcnt lgkmcnt(0)
  v_mfma_f32_16x16x32_bf16 v[40:43], v[124:127], v[128:131], v[40:43]
  v_mfma_f32_16x16x32_bf16 v[48:51], v[124:127], v[132:135], v[48:51]
  v_mfma_f32_16x16x32_bf16 v[56:59], v[124:127], v[136:139], v[56:59]
  v_cvt_pk_bf16_f32 v60, v36, v37
  v_cvt_pk_bf16_f32 v61, v38, v39
  ds_write_b64 v35, v[60:61] offset:0
  v_cvt_pk_bf16_f32 v64, v44, v45
  v_cvt_pk_bf16_f32 v65, v46, v47
  ds_write_b64 v35, v[64:65] offset:4096
  v_cvt_pk_bf16_f32 v68, v52, v53
  v_cvt_pk_bf16_f32 v69, v54, v55
  ds_write_b64 v35, v[68:69] offset:8192
  v_cvt_pk_bf16_f32 v62, v40, v41
  v_cvt_pk_bf16_f32 v63, v42, v43
  ds_write_b64 v35, v[62:63] offset:512
  v_cvt_pk_bf16_f32 v66, v48, v49
  v_cvt_pk_bf16_f32 v67, v50, v51
  ds_write_b64 v35, v[66:67] offset:4608
  v_cvt_pk_bf16_f32 v70, v56, v57
  v_cvt_pk_bf16_f32 v71, v58, v59
  ds_write_b64 v35, v[70:71] offset:8704
  s_cmp_eq_u32 s3, 3
  s_cbranch_scc1 L_w3
  s_waitcnt lgkmcnt(0)
  s_barrier
  ds_read_b128 v[52:55], v14 offset:32768
  ds_read_b128 v[36:39], v1 offset:0
  ds_read_b128 v[56:59], v15 offset:32768
  ds_read_b128 v[40:43], v1 offset:1024
  ds_read_b128 v[60:63], v16 offset:32768
  ds_read_b128 v[44:47], v1 offset:2048
  ds_read_b128 v[64:67], v17 offset:32768
  ds_read_b128 v[48:51], v1 offset:3072
  ds_read_b128 v[68:71], v14 offset:36864
  ds_read_b128 v[72:75], v15 offset:36864
  ds_read_b128 v[76:79], v16 offset:36864
  s_waitcnt lgkmcnt(9)
  v_mfma_f32_16x16x32_bf16 v[160:163], v[52:55], v[36:39], 0
  ds_read_b128 v[80:83], v17 offset:36864
  ds_read_b128 v[84:87], v14 offset:40960
  s_waitcnt lgkmcnt(9)
  v_mfma_f32_16x16x32_bf16 v[160:163], v[56:59], v[40:43], v[160:163]
  ds_read_b128 v[88:91], v15 offset:40960
  ds_read_b128 v[92:95], v16 offset:40960
  s_waitcnt lgkmcnt(9)
  v_mfma_f32_16x16x32_bf16 v[160:163], v[60:63], v[44:47], v[160:163]
  ds_read_b128 v[96:99], v17 offset:40960
  ds_read_b128 v[100:103], v14 offset:45056
  s_waitcnt lgkmcnt(9)
  v_mfma_f32_16x16x32_bf16 v[160:163], v[64:67], v[48:51], v[160:163]
  ds_read_b128 v[104:107], v15 offset:45056
  s_waitcnt lgkmcnt(9)
  v_mfma_f32_16x16x32_bf16 v[164:167], v[68:71], v[36:39], 0
  ds_read_b128 v[108:111], v16 offset:45056
  s_waitcnt lgkmcnt(9)
  v_mfma_f32_16x16x32_bf16 v[164:167], v[72:75], v[40:43], v[164:167]
  ds_read_b128 v[112:115], v17 offset:45056
  s_waitcnt lgkmcnt(9)
  v_mfma_f32_16x16x32_bf16 v[164:167], v[76:79], v[44:47], v[164:167]
  ds_read_b128 v[52:55], v14 offset:49152
  s_waitcnt lgkmcnt(9)
  v_mfma_f32_16x16x32_bf16 v[164:167], v[80:83], v[48:51], v[164:167]
  s_waitcnt lgkmcnt(8)
  ds_read_b128 v[56:59], v15 offset:49152
  v_max_f32 v156, v160, v161
  v_mfma_f32_16x16x32_bf16 v[168:171], v[84:87], v[36:39], 0
  s_waitcnt lgkmcnt(8)
  ds_read_b128 v[60:63], v16 offset:49152
  v_max3_f32 v156, v156, v162, v163
  v_mfma_f32_16x16x32_bf16 v[168:171], v[88:91], v[40:43], v[168:171]
  ds_read_b128 v[64:67], v17 offset:49152
  s_waitcnt lgkmcnt(9)
  v_mfma_f32_16x16x32_bf16 v[168:171], v[92:95], v[44:47], v[168:171]
  s_waitcnt lgkmcnt(8)
  ds_read_b128 v[68:71], v14 offset:53248
  v_max3_f32 v156, v156, v164, v165
  v_mfma_f32_16x16x32_bf16 v[168:171], v[96:99], v[48:51], v[168:171]
  s_waitcnt lgkmcnt(8)
  ds_read_b128 v[72:75], v15 offset:53248
  v_max3_f32 v156, v156, v166, v167
  v_mfma_f32_16x16x32_bf16 v[172:175], v[100:103], v[36:39], 0
  ds_read_b128 v[76:79], v16 offset:53248
  s_waitcnt lgkmcnt(9)
  v_mfma_f32_16x16x32_bf16 v[172:175], v[104:107], v[40:43], v[172:175]
  ds_read_b128 v[80:83], v17 offset:53248
  s_waitcnt lgkmcnt(9)
  v_mfma_f32_16x16x32_bf16 v[172:175], v[108:111], v[44:47], v[172:175]
  s_waitcnt lgkmcnt(8)
  v_max3_f32 v156, v156, v168, v169
  v_max3_f32 v156, v156, v170, v171
  v_mfma_f32_16x16x32_bf16 v[172:175], v[112:115], v[48:51], v[172:175]
  s_waitcnt lgkmcnt(7)
  v_mfma_f32_16x16x32_bf16 v[176:179], v[52:55], v[36:39], 0
  s_waitcnt lgkmcnt(6)
  v_mfma_f32_16x16x32_bf16 v[176:179], v[56:59], v[40:43], v[176:179]
  s_waitcnt lgkmcnt(5)
  v_mfma_f32_16x16x32_bf16 v[176:179], v[60:63], v[44:47], v[176:179]
  s_waitcnt lgkmcnt(4)
  v_mfma_f32_16x16x32_bf16 v[176:179], v[64:67], v[48:51], v[176:179]
  s_waitcnt lgkmcnt(3)
  v_mfma_f32_16x16x32_bf16 v[180:183], v[68:71], v[36:39], 0
  s_waitcnt lgkmcnt(2)
  v_max3_f32 v156, v156, v172, v173
  v_mfma_f32_16x16x32_bf16 v[180:183], v[72:75], v[40:43], v[180:183]
  s_waitcnt lgkmcnt(1)
  v_max3_f32 v156, v156, v174, v175
  v_mfma_f32_16x16x32_bf16 v[180:183], v[76:79], v[44:47], v[180:183]
  s_waitcnt lgkmcnt(0)
  s_barrier
  ds_read_b128 v[84:87], v8 offset:0
  ds_read_b128 v[88:91], v9 offset:0
  ds_read_b128 v[92:95], v10 offset:0
  ds_read_b128 v[96:99], v11 offset:0
  ds_read_b128 v[100:103], v8 offset:4096
  ds_read_b128 v[104:107], v9 offset:4096
  ds_read_b128 v[108:111], v10 offset:4096
  v_max3_f32 v156, v156, v176, v177
  v_mfma_f32_16x16x32_bf16 v[180:183], v[80:83], v[48:51], v[180:183]
  ds_read_b128 v[112:115], v11 offset:4096
  v_max3_f32 v156, v156, v178, v179
  ds_read_b128 v[52:55], v8 offset:8192
  ds_read_b128 v[56:59], v9 offset:8192
  s_waitcnt lgkmcnt(9)
  v_mfma_f32_16x16x32_bf16 v[184:187], v[84:87], v[36:39], 0
  ds_read_b128 v[60:63], v10 offset:8192
  s_waitcnt lgkmcnt(9)
  v_mfma_f32_16x16x32_bf16 v[184:187], v[88:91], v[40:43], v[184:187]
  s_waitcnt lgkmcnt(8)
  ds_read_b128 v[64:67], v11 offset:8192
  v_max3_f32 v156, v156, v180, v181
  v_mfma_f32_16x16x32_bf16 v[184:187], v[92:95], v[44:47], v[184:187]
  s_waitcnt lgkmcnt(8)
  ds_read_b128 v[68:71], v8 offset:12288
  v_max3_f32 v156, v156, v182, v183
  v_mfma_f32_16x16x32_bf16 v[184:187], v[96:99], v[48:51], v[184:187]
  ds_read_b128 v[72:75], v9 offset:12288
  s_waitcnt lgkmcnt(9)
  v_mfma_f32_16x16x32_bf16 v[188:191], v[100:103], v[36:39], 0
  ds_read_b128 v[76:79], v10 offset:12288
  s_waitcnt lgkmcnt(9)
  v_mfma_f32_16x16x32_bf16 v[188:191], v[104:107], v[40:43], v[188:191]
  ds_read_b128 v[80:83], v11 offset:12288
  s_waitcnt lgkmcnt(9)
  v_mfma_f32_16x16x32_bf16 v[188:191], v[108:111], v[44:47], v[188:191]
  ds_read_b128 v[84:87], v8 offset:16384
  s_waitcnt lgkmcnt(9)
  v_mfma_f32_16x16x32_bf16 v[188:191], v[112:115], v[48:51], v[188:191]
  s_waitcnt lgkmcnt(8)
  ds_read_b128 v[88:91], v9 offset:16384
  v_max3_f32 v156, v156, v184, v185
  v_mfma_f32_16x16x32_bf16 v[192:195], v[52:55], v[36:39], 0
  s_waitcnt lgkmcnt(8)
  ds_read_b128 v[92:95], v10 offset:16384
  v_max3_f32 v156, v156, v186, v187
  v_mfma_f32_16x16x32_bf16 v[192:195], v[56:59], v[40:43], v[192:195]
  ds_read_b128 v[96:99], v11 offset:16384
  s_waitcnt lgkmcnt(9)
  v_mfma_f32_16x16x32_bf16 v[192:195], v[60:63], v[44:47], v[192:195]
  s_waitcnt lgkmcnt(8)
  ds_read_b128 v[100:103], v8 offset:20480
  v_max3_f32 v156, v156, v188, v189
  v_mfma_f32_16x16x32_bf16 v[192:195], v[64:67], v[48:51], v[192:195]
  s_waitcnt lgkmcnt(8)
  ds_read_b128 v[104:107], v9 offset:20480
  v_max3_f32 v156, v156, v190, v191
  v_mfma_f32_16x16x32_bf16 v[196:199], v[68:71], v[36:39], 0
  ds_read_b128 v[108:111], v10 offset:20480
  s_waitcnt lgkmcnt(9)
  v_mfma_f32_16x16x32_bf16 v[196:199], v[72:75], v[40:43], v[196:199]
  ds_read_b128 v[112:115], v11 offset:20480
  s_waitcnt lgkmcnt(9)
  v_mfma_f32_16x16x32_bf16 v[196:199], v[76:79], v[44:47], v[196:199]
  s_waitcnt lgkmcnt(8)
  v_max3_f32 v156, v156, v192, v193
  v_max3_f32 v156, v156, v194, v195
  v_mfma_f32_16x16x32_bf16 v[196:199], v[80:83], v[48:51], v[196:199]
  s_waitcnt lgkmcnt(7)
  v_mfma_f32_16x16x32_bf16 v[200:203], v[84:87], v[36:39], 0
  s_waitcnt lgkmcnt(6)
  v_mfma_f32_16x16x32_bf16 v[200:203], v[88:91], v[40:43], v[200:203]
  s_waitcnt lgkmcnt(5)
  v_mfma_f32_16x16x32_bf16 v[200:203], v[92:95], v[44:47], v[200:203]
  s_waitcnt lgkmcnt(4)
  v_mfma_f32_16x16x32_bf16 v[200:203], v[96:99], v[48:51], v[200:203]
  s_waitcnt lgkmcnt(3)
  v_mfma_f32_16x16x32_bf16 v[204:207], v[100:103], v[36:39], 0
  s_waitcnt lgkmcnt(2)
  v_max3_f32 v156, v156, v196, v197
  v_mfma_f32_16x16x32_bf16 v[204:207], v[104:107], v[40:43], v[204:207]
  s_waitcnt lgkmcnt(1)
  v_max3_f32 v156, v156, v198, v199
  v_mfma_f32_16x16x32_bf16 v[204:207], v[108:111], v[44:47], v[204:207]
  s_waitcnt lgkmcnt(0)
  s_barrier
  ds_read_b128 v[52:55], v8 offset:32768
  ds_read_b128 v[56:59], v9 offset:32768
  ds_read_b128 v[60:63], v10 offset:32768
  ds_read_b128 v[64:67], v11 offset:32768
  ds_read_b128 v[68:71], v8 offset:36864
  ds_read_b128 v[72:75], v9 offset:36864
  ds_read_b128 v[76:79], v10 offset:36864
  v_max3_f32 v156, v156, v200, v201
  v_mfma_f32_16x16x32_bf16 v[204:207], v[112:115], v[48:51], v[204:207]
  ds_read_b128 v[80:83], v11 offset:36864
  v_max3_f32 v156, v156, v202, v203
  ds_read_b128 v[84:87], v8 offset:40960
  ds_read_b128 v[88:91], v9 offset:40960
  s_waitcnt lgkmcnt(9)
  v_mfma_f32_16x16x32_bf16 v[208:211], v[52:55], v[36:39], 0
  ds_read_b128 v[92:95], v10 offset:40960
  s_waitcnt lgkmcnt(9)
  v_mfma_f32_16x16x32_bf16 v[208:211], v[56:59], v[40:43], v[208:211]
  s_waitcnt lgkmcnt(8)
  ds_read_b128 v[96:99], v11 offset:40960
  v_max3_f32 v156, v156, v204, v205
  v_mfma_f32_16x16x32_bf16 v[208:211], v[60:63], v[44:47], v[208:211]
  s_waitcnt lgkmcnt(8)
  ds_read_b128 v[100:103], v8 offset:45056
  v_max3_f32 v156, v156, v206, v207
  v_mfma_f32_16x16x32_bf16 v[208:211], v[64:67], v[48:51], v[208:211]
  ds_read_b128 v[104:107], v9 offset:45056
  s_waitcnt lgkmcnt(9)
  v_mfma_f32_16x16x32_bf16 v[212:215], v[68:71], v[36:39], 0
  ds_read_b128 v[108:111], v10 offset:45056
  s_waitcnt lgkmcnt(9)
  v_mfma_f32_16x16x32_bf16 v[212:215], v[72:75], v[40:43], v[212:215]
  ds_read_b128 v[112:115], v11 offset:45056
  s_waitcnt lgkmcnt(9)
  v_mfma_f32_16x16x32_bf16 v[212:215], v[76:79], v[44:47], v[212:215]
  ds_read_b128 v[52:55], v8 offset:49152
  s_waitcnt lgkmcnt(9)
  v_mfma_f32_16x16x32_bf16 v[212:215], v[80:83], v[48:51], v[212:215]
  s_waitcnt lgkmcnt(8)
  ds_read_b128 v[56:59], v9 offset:49152
  v_max3_f32 v156, v156, v208, v209
  v_mfma_f32_16x16x32_bf16 v[216:219], v[84:87], v[36:39], 0
  s_waitcnt lgkmcnt(8)
  ds_read_b128 v[60:63], v10 offset:49152
  v_max3_f32 v156, v156, v210, v211
  v_mfma_f32_16x16x32_bf16 v[216:219], v[88:91], v[40:43], v[216:219]
  ds_read_b128 v[64:67], v11 offset:49152
  s_waitcnt lgkmcnt(9)
  v_mfma_f32_16x16x32_bf16 v[216:219], v[92:95], v[44:47], v[216:219]
  s_waitcnt lgkmcnt(8)
  ds_read_b128 v[68:71], v8 offset:53248
  v_max3_f32 v156, v156, v212, v213
  v_mfma_f32_16x16x32_bf16 v[216:219], v[96:99], v[48:51], v[216:219]
  s_waitcnt lgkmcnt(8)
  ds_read_b128 v[72:75], v9 offset:53248
  v_max3_f32 v156, v156, v214, v215
  v_mfma_f32_16x16x32_bf16 v[220:223], v[100:103], v[36:39], 0
  ds_read_b128 v[76:79], v10 offset:53248
  s_waitcnt lgkmcnt(9)
  v_mfma_f32_16x16x32_bf16 v[220:223], v[104:107], v[40:43], v[220:223]
  ds_read_b128 v[80:83], v11 offset:53248
  s_waitcnt lgkmcnt(9)
  v_mfma_f32_16x16x32_bf16 v[220:223], v[108:111], v[44:47], v[220:223]
  s_waitcnt lgkmcnt(8)
  v_max3_f32 v156, v156, v216, v217
  v_max3_f32 v156, v156, v218, v219
  v_mfma_f32_16x16x32_bf16 v[220:223], v[112:115], v[48:51], v[220:223]
  s_waitcnt lgkmcnt(7)
  v_mfma_f32_16x16x32_bf16 v[224:227], v[52:55], v[36:39], 0
  s_waitcnt lgkmcnt(6)
  v_mfma_f32_16x16x32_bf16 v[224:227], v[56:59], v[40:43], v[224:227]
  s_waitcnt lgkmcnt(5)
  v_mfma_f32_16x16x32_bf16 v[224:227], v[60:63], v[44:47], v[224:227]
  s_waitcnt lgkmcnt(4)
  v_mfma_f32_16x16x32_bf16 v[224:227], v[64:67], v[48:51], v[224:227]
  s_waitcnt lgkmcnt(3)
  v_mfma_f32_16x16x32_bf16 v[228:231], v[68:71], v[36:39], 0
  s_waitcnt lgkmcnt(2)
  v_max3_f32 v156, v156, v220, v221
  v_mfma_f32_16x16x32_bf16 v[228:231], v[72:75], v[40:43], v[228:231]
  s_waitcnt lgkmcnt(1)
  v_max3_f32 v156, v156, v222, v223
  v_mfma_f32_16x16x32_bf16 v[228:231], v[76:79], v[44:47], v[228:231]
  s_waitcnt lgkmcnt(0)
  s_barrier
  ds_read_b128 v[84:87], v14 offset:0
  ds_read_b128 v[88:91], v15 offset:0
  ds_read_b128 v[92:95], v16 offset:0
  ds_read_b128 v[96:99], v17 offset:0
  ds_read_b128 v[100:103], v14 offset:4096
  ds_read_b128 v[104:107], v15 offset:4096
  ds_read_b128 v[108:111], v16 offset:4096
  v_max3_f32 v156, v156, v224, v225
  v_mfma_f32_16x16x32_bf16 v[228:231], v[80:83], v[48:51], v[228:231]
  ds_read_b128 v[112:115], v17 offset:4096
  v_max3_f32 v156, v156, v226, v227
  ds_read_b128 v[52:55], v14 offset:8192
  ds_read_b128 v[56:59], v15 offset:8192
  s_waitcnt lgkmcnt(9)
  v_mfma_f32_16x16x32_bf16 v[232:235], v[84:87], v[36:39], 0
  ds_read_b128 v[60:63], v16 offset:8192
  s_waitcnt lgkmcnt(9)
  v_mfma_f32_16x16x32_bf16 v[232:235], v[88:91], v[40:43], v[232:235]
  s_waitcnt lgkmcnt(8)
  ds_read_b128 v[64:67], v17 offset:8192
  v_max3_f32 v156, v156, v228, v229
  v_mfma_f32_16x16x32_bf16 v[232:235], v[92:95], v[44:47], v[232:235]
  s_waitcnt lgkmcnt(8)
  ds_read_b128 v[68:71], v14 offset:12288
  v_max3_f32 v156, v156, v230, v231
  v_mfma_f32_16x16x32_bf16 v[232:235], v[96:99], v[48:51], v[232:235]
  ds_read_b128 v[72:75], v15 offset:12288
  s_waitcnt lgkmcnt(9)
  v_mfma_f32_16x16x32_bf16 v[236:239], v[100:103], v[36:39], 0
  ds_read_b128 v[76:79], v16 offset:12288
  s_waitcnt lgkmcnt(9)
  v_mfma_f32_16x16x32_bf16 v[236:239], v[104:107], v[40:43], v[236:239]
  ds_read_b128 v[80:83], v17 offset:12288
  s_waitcnt lgkmcnt(9)
  v_mfma_f32_16x16x32_bf16 v[236:239], v[108:111], v[44:47], v[236:239]
  ds_read_b128 v[84:87], v14 offset:16384
  s_waitcnt lgkmcnt(9)
  v_mfma_f32_16x16x32_bf16 v[236:239], v[112:115], v[48:51], v[236:239]
  s_waitcnt lgkmcnt(8)
  ds_read_b128 v[88:91], v15 offset:16384
  v_max3_f32 v156, v156, v232, v233
  v_mfma_f32_16x16x32_bf16 v[240:243], v[52:55], v[36:39], 0
  s_waitcnt lgkmcnt(8)
  ds_read_b128 v[92:95], v16 offset:16384
  v_max3_f32 v156, v156, v234, v235
  v_mfma_f32_16x16x32_bf16 v[240:243], v[56:59], v[40:43], v[240:243]
  ds_read_b128 v[96:99], v17 offset:16384
  s_waitcnt lgkmcnt(9)
  v_mfma_f32_16x16x32_bf16 v[240:243], v[60:63], v[44:47], v[240:243]
  s_waitcnt lgkmcnt(8)
  ds_read_b128 v[100:103], v14 offset:20480
  v_max3_f32 v156, v156, v236, v237
  v_mfma_f32_16x16x32_bf16 v[240:243], v[64:67], v[48:51], v[240:243]
  s_waitcnt lgkmcnt(8)
  ds_read_b128 v[104:107], v15 offset:20480
  v_max3_f32 v156, v156, v238, v239
  v_mfma_f32_16x16x32_bf16 v[244:247], v[68:71], v[36:39], 0
  ds_read_b128 v[108:111], v16 offset:20480
  s_waitcnt lgkmcnt(9)
  v_mfma_f32_16x16x32_bf16 v[244:247], v[72:75], v[40:43], v[244:247]
  ds_read_b128 v[112:115], v17 offset:20480
  s_waitcnt lgkmcnt(9)
  v_mfma_f32_16x16x32_bf16 v[244:247], v[76:79], v[44:47], v[244:247]
  s_waitcnt lgkmcnt(8)
  ds_add_u32 v32, v4
  v_max3_f32 v156, v156, v240, v241
  v_mfma_f32_16x16x32_bf16 v[244:247], v[80:83], v[48:51], v[244:247]
  s_waitcnt lgkmcnt(8)
  v_max3_f32 v156, v156, v242, v243
  v_mfma_f32_16x16x32_bf16 v[248:251], v[84:87], v[36:39], 0
  s_waitcnt lgkmcnt(7)
  v_mfma_f32_16x16x32_bf16 v[248:251], v[88:91], v[40:43], v[248:251]
  s_waitcnt lgkmcnt(6)
  v_mfma_f32_16x16x32_bf16 v[248:251], v[92:95], v[44:47], v[248:251]
  s_waitcnt lgkmcnt(5)
  v_mfma_f32_16x16x32_bf16 v[248:251], v[96:99], v[48:51], v[248:251]
  s_waitcnt lgkmcnt(4)
  v_max3_f32 v156, v156, v244, v245
  v_mfma_f32_16x16x32_bf16 v[252:255], v[100:103], v[36:39], 0
  s_waitcnt lgkmcnt(3)
  v_max3_f32 v156, v156, v246, v247
  v_mfma_f32_16x16x32_bf16 v[252:255], v[104:107], v[40:43], v[252:255]
  s_waitcnt lgkmcnt(2)
  v_mfma_f32_16x16x32_bf16 v[252:255], v[108:111], v[44:47], v[252:255]
  s_waitcnt lgkmcnt(1)
  v_max3_f32 v156, v156, v248, v249
  v_mfma_f32_16x16x32_bf16 v[252:255], v[112:115], v[48:51], v[252:255]
  v_max3_f32 v156, v156, v250, v251
  s_nop 6
  v_max3_f32 v156, v156, v252, v253
  v_max3_f32 v156, v156, v254, v255
  v_mov_b32 v157, v156
  s_nop 1
  v_permlane32_swap_b32 v157, v156
  v_max_f32 v156, v156, v157
  v_mov_b32 v157, v156
  s_nop 1
  v_permlane16_swap_b32 v157, v156
  v_max_f32 v156, v156, v157
  v_mul_f32 v156, s63, v156
  v_fma_f32 v160, v160, s63, -v156
  v_fma_f32 v161, v161, s63, -v156
  v_exp_f32 v160, v160
  v_fma_f32 v162, v162, s63, -v156
  v_exp_f32 v161, v161
  v_fma_f32 v163, v163, s63, -v156
  v_exp_f32 v162, v162
  v_fma_f32 v164, v164, s63, -v156
  v_exp_f32 v163, v163
  v_fma_f32 v165, v165, s63, -v156
  v_exp_f32 v164, v164
  v_fma_f32 v166, v166, s63, -v156
  v_exp_f32 v165, v165
  v_fma_f32 v167, v167, s63, -v156
  v_exp_f32 v166, v166
  v_cvt_pk_bf16_f32 v160, v160, v161
  v_exp_f32 v167, v167
  v_cvt_pk_bf16_f32 v161, v162, v163
  v_cvt_pk_bf16_f32 v162, v164, v165
  v_cvt_pk_bf16_f32 v163, v166, v167
  v_fma_f32 v168, v168, s63, -v156
  v_fma_f32 v169, v169, s63, -v156
  v_mfma_f32_16x16x32_bf16 v[132:135], v[148:151], v[160:163], 0
  v_exp_f32 v168, v168
  v_fma_f32 v170, v170, s63, -v156
  v_exp_f32 v169, v169
  v_fma_f32 v171, v171, s63, -v156
  v_exp_f32 v170, v170
  v_fma_f32 v172, v172, s63, -v156
  v_exp_f32 v171, v171
  v_fma_f32 v173, v173, s63, -v156
  v_exp_f32 v172, v172
  v_fma_f32 v174, v174, s63, -v156
  v_exp_f32 v173, v173
  v_fma_f32 v175, v175, s63, -v156
  v_exp_f32 v174, v174
  v_cvt_pk_bf16_f32 v168, v168, v169
  v_exp_f32 v175, v175
  v_cvt_pk_bf16_f32 v169, v170, v171
  v_cvt_pk_bf16_f32 v170, v172, v173
  v_cvt_pk_bf16_f32 v171, v174, v175
  v_fma_f32 v176, v176, s63, -v156
  v_fma_f32 v177, v177, s63, -v156
  v_mfma_f32_16x16x32_bf16 v[132:135], v[148:151], v[168:171], v[132:135]
  v_exp_f32 v176, v176
  v_fma_f32 v178, v178, s63, -v156
  v_exp_f32 v177, v177
  v_fma_f32 v179, v179, s63, -v156
  v_exp_f32 v178, v178
  v_fma_f32 v180, v180, s63, -v156
  v_exp_f32 v179, v179
  v_fma_f32 v181, v181, s63, -v156
  v_exp_f32 v180, v180
  v_fma_f32 v182, v182, s63, -v156
  v_exp_f32 v181, v181
  v_fma_f32 v183, v183, s63, -v156
  v_exp_f32 v182, v182
  v_cvt_pk_bf16_f32 v176, v176, v177
  v_exp_f32 v183, v183
  v_cvt_pk_bf16_f32 v177, v178, v179
  v_cvt_pk_bf16_f32 v178, v180, v181
  v_cvt_pk_bf16_f32 v179, v182, v183
  v_fma_f32 v184, v184, s63, -v156
  v_fma_f32 v185, v185, s63, -v156
  v_mfma_f32_16x16x32_bf16 v[132:135], v[148:151], v[176:179], v[132:135]
  v_exp_f32 v184, v184
  v_fma_f32 v186, v186, s63, -v156
  v_exp_f32 v185, v185
  v_fma_f32 v187, v187, s63, -v156
  v_exp_f32 v186, v186
  v_fma_f32 v188, v188, s63, -v156
  v_exp_f32 v187, v187
  v_fma_f32 v189, v189, s63, -v156
  v_exp_f32 v188, v188
  v_fma_f32 v190, v190, s63, -v156
  v_exp_f32 v189, v189
  v_fma_f32 v191, v191, s63, -v156
  v_exp_f32 v190, v190
  v_cvt_pk_bf16_f32 v184, v184, v185
  v_exp_f32 v191, v191
  v_cvt_pk_bf16_f32 v185, v186, v187
  v_cvt_pk_bf16_f32 v186, v188, v189
  v_cvt_pk_bf16_f32 v187, v190, v191
  v_fma_f32 v192, v192, s63, -v156
  v_fma_f32 v193, v193, s63, -v156
  v_mfma_f32_16x16x32_bf16 v[132:135], v[148:151], v[184:187], v[132:135]
  v_exp_f32 v192, v192
  v_fma_f32 v194, v194, s63, -v156
  v_exp_f32 v193, v193
  v_fma_f32 v195, v195, s63, -v156
  v_exp_f32 v194, v194
  v_fma_f32 v196, v196, s63, -v156
  v_exp_f32 v195, v195
  v_fma_f32 v197, v197, s63, -v156
  v_exp_f32 v196, v196
  v_fma_f32 v198, v198, s63, -v156
  v_exp_f32 v197, v197
  v_fma_f32 v199, v199, s63, -v156
  v_exp_f32 v198, v198
  v_cvt_pk_bf16_f32 v192, v192, v193
  v_exp_f32 v199, v199
  v_cvt_pk_bf16_f32 v193, v194, v195
  v_cvt_pk_bf16_f32 v194, v196, v197
  v_cvt_pk_bf16_f32 v195, v198, v199
  v_fma_f32 v200, v200, s63, -v156
  v_fma_f32 v201, v201, s63, -v156
  v_mfma_f32_16x16x32_bf16 v[132:135], v[148:151], v[192:195], v[132:135]
  v_exp_f32 v200, v200
  v_fma_f32 v202, v202, s63, -v156
  v_exp_f32 v201, v201
  v_fma_f32 v203, v203, s63, -v156
  v_exp_f32 v202, v202
  v_fma_f32 v204, v204, s63, -v156
  v_exp_f32 v203, v203
  v_fma_f32 v205, v205, s63, -v156
  v_exp_f32 v204, v204
  v_fma_f32 v206, v206, s63, -v156
  v_exp_f32 v205, v205
  v_fma_f32 v207, v207, s63, -v156
  v_exp_f32 v206, v206
  v_cvt_pk_bf16_f32 v200, v200, v201
  v_exp_f32 v207, v207
  v_cvt_pk_bf16_f32 v201, v202, v203
  v_cvt_pk_bf16_f32 v202, v204, v205
  ds_read_b32 v3, v30 offset:0
  v_cvt_pk_bf16_f32 v203, v206, v207
  v_fma_f32 v208, v208, s63, -v156
  v_fma_f32 v209, v209, s63, -v156
  v_mfma_f32_16x16x32_bf16 v[132:135], v[148:151], v[200:203], v[132:135]
  v_exp_f32 v208, v208
  v_fma_f32 v210, v210, s63, -v156
  v_exp_f32 v209, v209
  v_fma_f32 v211, v211, s63, -v156
  v_exp_f32 v210, v210
  v_fma_f32 v212, v212, s63, -v156
  v_exp_f32 v211, v211
  v_fma_f32 v213, v213, s63, -v156
  s_waitcnt lgkmcnt(0)
  v_cmp_ne_u32 vcc, 0, v3
  v_exp_f32 v212, v212
  v_fma_f32 v214, v214, s63, -v156
  v_exp_f32 v213, v213
  v_fma_f32 v215, v215, s63, -v156
  s_cbranch_vccnz LS_c1
LK_c1:
  ds_read_b64_tr_b16 v[68:69], v18 offset:32768
  ds_read_b64_tr_b16 v[70:71], v18 offset:36864
  ds_read_b64_tr_b16 v[72:73], v19 offset:32768
  ds_read_b64_tr_b16 v[74:75], v19 offset:36864
  ds_read_b64_tr_b16 v[76:77], v20 offset:32768
  ds_read_b64_tr_b16 v[78:79], v20 offset:36864
  ds_read_b64_tr_b16 v[80:81], v21 offset:32768
  ds_read_b64_tr_b16 v[82:83], v21 offset:36864
  ds_read_b64_tr_b16 v[84:85], v22 offset:32768
  ds_read_b64_tr_b16 v[86:87], v22 offset:36864
  ds_read_b64_tr_b16 v[88:89], v23 offset:32768
  v_exp_f32 v214, v214
  v_cvt_pk_bf16_f32 v208, v208, v209
  v_exp_f32 v215, v215
  v_cvt_pk_bf16_f32 v209, v210, v211
  v_cvt_pk_bf16_f32 v210, v212, v213
  v_cvt_pk_bf16_f32 v211, v214, v215
  v_fma_f32 v216, v216, s63, -v156
  s_waitcnt lgkmcnt(9)
  v_mfma_f32_16x16x32_bf16 v[36:39], v[68:71], v[160:163], 0
  ds_read_b64_tr_b16 v[90:91], v23 offset:36864
  ds_read_b64_tr_b16 v[92:93], v24 offset:32768
  ds_read_b64_tr_b16 v[94:95], v24 offset:36864
  ds_read_b64_tr_b16 v[96:97], v25 offset:32768
  ds_read_b64_tr_b16 v[98:99], v25 offset:36864
  ds_read_b64_tr_b16 v[100:101], v18 offset:49152
  ds_read_b64_tr_b16 v[102:103], v18 offset:53248
  ds_read_b64_tr_b16 v[104:105], v19 offset:49152
  ds_read_b64_tr_b16 v[106:107], v19 offset:53248
  ds_read_b64_tr_b16 v[108:109], v20 offset:49152
  ds_read_b64_tr_b16 v[110:111], v20 offset:53248
  v_fma_f32 v217, v217, s63, -v156
  v_mfma_f32_16x16x32_bf16 v[132:135], v[148:151], v[208:211], v[132:135]
  s_waitcnt lgkmcnt(15)
  ds_read_b64_tr_b16 v[112:113], v21 offset:49152
  v_exp_f32 v216, v216
  v_mfma_f32_16x16x32_bf16 v[40:43], v[72:75], v[160:163], 0
  ds_read_b64_tr_b16 v[114:115], v21 offset:53248
  v_fma_f32 v218, v218, s63, -v156
  v_mfma_f32_16x16x32_bf16 v[44:47], v[76:79], v[160:163], 0
  ds_read_b64_tr_b16 v[116:117], v22 offset:49152
  ds_read_b64_tr_b16 v[118:119], v22 offset:53248
  v_exp_f32 v217, v217
  v_mfma_f32_16x16x32_bf16 v[48:51], v[80:83], v[160:163], 0
  s_waitcnt lgkmcnt(15)
  ds_read_b64_tr_b16 v[120:121], v23 offset:49152
  ds_read_b64_tr_b16 v[122:123], v23 offset:53248
  v_fma_f32 v219, v219, s63, -v156
  v_mfma_f32_16x16x32_bf16 v[52:55], v[84:87], v[160:163], 0
  ds_read_b64_tr_b16 v[124:125], v24 offset:49152
  ds_read_b64_tr_b16 v[126:127], v24 offset:53248
  v_exp_f32 v218, v218
  v_mfma_f32_16x16x32_bf16 v[56:59], v[88:91], v[160:163], 0
  s_waitcnt lgkmcnt(15)
  ds_read_b64_tr_b16 v[128:129], v25 offset:49152
  ds_read_b64_tr_b16 v[130:131], v25 offset:53248
  v_fma_f32 v220, v220, s63, -v156
  v_mfma_f32_16x16x32_bf16 v[60:63], v[92:95], v[160:163], 0
  ds_read_b64_tr_b16 v[68:69], v18 offset:57344
  ds_read_b64_tr_b16 v[70:71], v18 offset:61440
  v_exp_f32 v219, v219
  v_mfma_f32_16x16x32_bf16 v[64:67], v[96:99], v[160:163], 0
  s_waitcnt lgkmcnt(15)
  ds_read_b64_tr_b16 v[72:73], v19 offset:57344
  ds_read_b64_tr_b16 v[74:75], v19 offset:61440
  v_fma_f32 v221, v221, s63, -v156
  v_mfma_f32_16x16x32_bf16 v[36:39], v[100:103], v[168:171], v[36:39]
  ds_read_b64_tr_b16 v[76:77], v20 offset:57344
  ds_read_b64_tr_b16 v[78:79], v20 offset:61440
  v_exp_f32 v220, v220
  v_mfma_f32_16x16x32_bf16 v[40:43], v[104:107], v[168:171], v[40:43]
  ds_read_b32 v3, v30 offset:400
  ds_read_b64_tr_b16 v[80:81], v21 offset:57344
  ds_read_b64_tr_b16 v[82:83], v21 offset:61440
  v_fma_f32 v222, v222, s63, -v156
  s_waitcnt lgkmcnt(15)
  v_mfma_f32_16x16x32_bf16 v[44:47], v[108:111], v[168:171], v[44:47]
  ds_read_b64_tr_b16 v[84:85], v22 offset:57344
  ds_read_b64_tr_b16 v[86:87], v22 offset:61440
  v_exp_f32 v221, v221
  v_mfma_f32_16x16x32_bf16 v[48:51], v[112:115], v[168:171], v[48:51]
  ds_read_b64_tr_b16 v[88:89], v23 offset:57344
  ds_read_b64_tr_b16 v[90:91], v23 offset:61440
  v_fma_f32 v223, v223, s63, -v156
  v_mfma_f32_16x16x32_bf16 v[52:55], v[116:119], v[168:171], v[52:55]
  s_waitcnt lgkmcnt(15)
  ds_read_b64_tr_b16 v[92:93], v24 offset:57344
  ds_read_b64_tr_b16 v[94:95], v24 offset:61440
  v_exp_f32 v222, v222
  v_mfma_f32_16x16x32_bf16 v[56:59], v[120:123], v[168:171], v[56:59]
  ds_read_b64_tr_b16 v[96:97], v25 offset:57344
  ds_read_b64_tr_b16 v[98:99], v25 offset:61440
  s_waitcnt lgkmcnt(10)
  v_cmp_ne_u32 vcc, 0, v3
  v_mfma_f32_16x16x32_bf16 v[60:63], v[124:127], v[168:171], v[60:63]
  v_cvt_pk_bf16_f32 v216, v216, v217
  v_exp_f32 v223, v223
  v_mfma_f32_16x16x32_bf16 v[64:67], v[128:131], v[168:171], v[64:67]
  s_cbranch_vccnz LS_c2
LK_c2:
  ds_read_b64_tr_b16 v[100:101], v140 offset:8192
  ds_read_b64_tr_b16 v[102:103], v140 offset:12288
  ds_read_b64_tr_b16 v[104:105], v141 offset:8192
  ds_read_b64_tr_b16 v[106:107], v141 offset:12288
  v_cvt_pk_bf16_f32 v217, v218, v219
  v_mfma_f32_16x16x32_bf16 v[36:39], v[68:71], v[176:179], v[36:39]
  ds_read_b64_tr_b16 v[108:109], v142 offset:8192
  ds_read_b64_tr_b16 v[110:111], v142 offset:12288
  v_cvt_pk_bf16_f32 v218, v220, v221
  v_mfma_f32_16x16x32_bf16 v[40:43], v[72:75], v[176:179], v[40:43]
  v_cvt_pk_bf16_f32 v219, v222, v223
  v_fma_f32 v224, v224, s63, -v156
  v_mfma_f32_16x16x32_bf16 v[44:47], v[76:79], v[176:179], v[44:47]
  ds_read_b32 v3, v30 offset:16
  ds_read_b64_tr_b16 v[112:113], v143 offset:8192
  ds_read_b64_tr_b16 v[114:115], v143 offset:12288
  ds_read_b64_tr_b16 v[116:117], v144 offset:8192
  ds_read_b64_tr_b16 v[118:119], v144 offset:12288
  v_fma_f32 v225, v225, s63, -v156
  v_mfma_f32_16x16x32_bf16 v[132:135], v[148:151], v[216:219], v[132:135]
  s_waitcnt lgkmcnt(15)
  ds_read_b64_tr_b16 v[120:121], v145 offset:8192
  v_exp_f32 v224, v224
  v_mfma_f32_16x16x32_bf16 v[48:51], v[80:83], v[176:179], v[48:51]
  ds_read_b64_tr_b16 v[122:123], v145 offset:12288
  v_fma_f32 v226, v226, s63, -v156
  v_mfma_f32_16x16x32_bf16 v[52:55], v[84:87], v[176:179], v[52:55]
  ds_read_b64_tr_b16 v[124:125], v146 offset:8192
  ds_read_b64_tr_b16 v[126:127], v146 offset:12288
  v_exp_f32 v225, v225
  v_mfma_f32_16x16x32_bf16 v[56:59], v[88:91], v[176:179], v[56:59]
  ds_read_b64_tr_b16 v[128:129], v147 offset:8192
  ds_read_b64_tr_b16 v[130:131], v147 offset:12288
  s_waitcnt lgkmcnt(10)
  v_cmp_ne_u32 vcc, 0, v3
  v_mfma_f32_16x16x32_bf16 v[60:63], v[92:95], v[176:179], v[60:63]
  v_fma_f32 v227, v227, s63, -v156
  v_exp_f32 v226, v226
  v_mfma_f32_16x16x32_bf16 v[64:67], v[96:99], v[176:179], v[64:67]
  s_cbranch_vccnz LS_c3
LK_c3:
  ds_read_b64_tr_b16 v[68:69], v140 offset:16384
  ds_read_b64_tr_b16 v[70:71], v140 offset:20480
  ds_read_b64_tr_b16 v[72:73], v141 offset:16384
  ds_read_b64_tr_b16 v[74:75], v141 offset:20480
  v_fma_f32 v228, v228, s63, -v156
  v_mfma_f32_16x16x32_bf16 v[36:39], v[100:103], v[184:187], v[36:39]
  ds_read_b64_tr_b16 v[76:77], v142 offset:16384
  ds_read_b64_tr_b16 v[78:79], v142 offset:20480
  v_exp_f32 v227, v227
  v_mfma_f32_16x16x32_bf16 v[40:43], v[104:107], v[184:187], v[40:43]
  ds_read_b64_tr_b16 v[80:81], v143 offset:16384
  ds_read_b64_tr_b16 v[82:83], v143 offset:20480
  v_fma_f32 v229, v229, s63, -v156
  v_mfma_f32_16x16x32_bf16 v[44:47], v[108:111], v[184:187], v[44:47]
  s_waitcnt lgkmcnt(15)
  ds_read_b64_tr_b16 v[84:85], v144 offset:16384
  ds_read_b64_tr_b16 v[86:87], v144 offset:20480
  v_exp_f32 v228, v228
  v_mfma_f32_16x16x32_bf16 v[48:51], v[112:115], v[184:187], v[48:51]
  ds_read_b64_tr_b16 v[88:89], v145 offset:16384
  ds_read_b64_tr_b16 v[90:91], v145 offset:20480
  v_fma_f32 v230, v230, s63, -v156
  v_mfma_f32_16x16x32_bf16 v[52:55], v[116:119], v[184:187], v[52:55]
  s_waitcnt lgkmcnt(15)
  ds_read_b64_tr_b16 v[92:93], v146 offset:16384
  ds_read_b64_tr_b16 v[94:95], v146 offset:20480
  v_exp_f32 v229, v229
  v_mfma_f32_16x16x32_bf16 v[56:59], v[120:123], v[184:187], v[56:59]
  ds_read_b64_tr_b16 v[96:97], v147 offset:16384
  ds_read_b64_tr_b16 v[98:99], v147 offset:20480
  v_fma_f32 v231, v231, s63, -v156
  v_mfma_f32_16x16x32_bf16 v[60:63], v[124:127], v[184:187], v[60:63]
  s_waitcnt lgkmcnt(15)
  ds_read_b64_tr_b16 v[100:101], v140 offset:24576
  ds_read_b64_tr_b16 v[102:103], v140 offset:28672
  v_exp_f32 v230, v230
  v_mfma_f32_16x16x32_bf16 v[64:67], v[128:131], v[184:187], v[64:67]
  ds_read_b64_tr_b16 v[104:105], v141 offset:24576
  ds_read_b64_tr_b16 v[106:107], v141 offset:28672
  v_cvt_pk_bf16_f32 v224, v224, v225
  v_mfma_f32_16x16x32_bf16 v[36:39], v[68:71], v[192:195], v[36:39]
  s_waitcnt lgkmcnt(15)
  ds_read_b64_tr_b16 v[108:109], v142 offset:24576
  ds_read_b64_tr_b16 v[110:111], v142 offset:28672
  v_exp_f32 v231, v231
  v_mfma_f32_16x16x32_bf16 v[40:43], v[72:75], v[192:195], v[40:43]
  ds_read_b32 v3, v30 offset:416
  ds_read_b64_tr_b16 v[112:113], v143 offset:24576
  ds_read_b64_tr_b16 v[114:115], v143 offset:28672
  v_cvt_pk_bf16_f32 v225, v226, v227
  v_mfma_f32_16x16x32_bf16 v[44:47], v[76:79], v[192:195], v[44:47]
  s_waitcnt lgkmcnt(15)
  ds_read_b64_tr_b16 v[116:117], v144 offset:24576
  ds_read_b64_tr_b16 v[118:119], v144 offset:28672
  v_cvt_pk_bf16_f32 v226, v228, v229
  v_mfma_f32_16x16x32_bf16 v[48:51], v[80:83], v[192:195], v[48:51]
  ds_read_b64_tr_b16 v[120:121], v145 offset:24576
  ds_read_b64_tr_b16 v[122:123], v145 offset:28672
  v_cvt_pk_bf16_f32 v227, v230, v231
  v_mfma_f32_16x16x32_bf16 v[52:55], v[84:87], v[192:195], v[52:55]
  ds_read_b64_tr_b16 v[124:125], v146 offset:24576
  ds_read_b64_tr_b16 v[126:127], v146 offset:28672
  v_fma_f32 v232, v232, s63, -v156
  v_mfma_f32_16x16x32_bf16 v[56:59], v[88:91], v[192:195], v[56:59]
  ds_read_b64_tr_b16 v[128:129], v147 offset:24576
  ds_read_b64_tr_b16 v[130:131], v147 offset:28672
  s_waitcnt lgkmcnt(10)
  v_cmp_ne_u32 vcc, 0, v3
  v_mfma_f32_16x16x32_bf16 v[60:63], v[92:95], v[192:195], v[60:63]
  v_fma_f32 v233, v233, s63, -v156
  v_mfma_f32_16x16x32_bf16 v[132:135], v[148:151], v[224:227], v[132:135]
  s_cbranch_vccnz LS_c4
LK_c4:
  ds_read_b64_tr_b16 v[68:69], v140 offset:40960
  ds_read_b64_tr_b16 v[70:71], v140 offset:45056
  v_exp_f32 v232, v232
  v_mfma_f32_16x16x32_bf16 v[64:67], v[96:99], v[192:195], v[64:67]
  ds_read_b64_tr_b16 v[72:73], v141 offset:40960
  ds_read_b64_tr_b16 v[74:75], v141 offset:45056
  v_fma_f32 v234, v234, s63, -v156
  v_mfma_f32_16x16x32_bf16 v[36:39], v[100:103], v[200:203], v[36:39]
  ds_read_b64_tr_b16 v[76:77], v142 offset:40960
  ds_read_b64_tr_b16 v[78:79], v142 offset:45056
  v_exp_f32 v233, v233
  v_mfma_f32_16x16x32_bf16 v[40:43], v[104:107], v[200:203], v[40:43]
  ds_read_b32 v3, v30 offset:32
  ds_read_b64_tr_b16 v[80:81], v143 offset:40960
  ds_read_b64_tr_b16 v[82:83], v143 offset:45056
  v_fma_f32 v235, v235, s63, -v156
  v_mfma_f32_16x16x32_bf16 v[44:47], v[108:111], v[200:203], v[44:47]
  s_waitcnt lgkmcnt(15)
  ds_read_b64_tr_b16 v[84:85], v144 offset:40960
  ds_read_b64_tr_b16 v[86:87], v144 offset:45056
  v_exp_f32 v234, v234
  v_mfma_f32_16x16x32_bf16 v[48:51], v[112:115], v[200:203], v[48:51]
  ds_read_b64_tr_b16 v[88:89], v145 offset:40960
  ds_read_b64_tr_b16 v[90:91], v145 offset:45056
  v_fma_f32 v236, v236, s63, -v156
  v_mfma_f32_16x16x32_bf16 v[52:55], v[116:119], v[200:203], v[52:55]
  ds_read_b64_tr_b16 v[92:93], v146 offset:40960
  ds_read_b64_tr_b16 v[94:95], v146 offset:45056
  v_exp_f32 v235, v235
  v_mfma_f32_16x16x32_bf16 v[56:59], v[120:123], v[200:203], v[56:59]
  ds_read_b64_tr_b16 v[96:97], v147 offset:40960
  ds_read_b64_tr_b16 v[98:99], v147 offset:45056
  s_waitcnt lgkmcnt(10)
  v_cmp_ne_u32 vcc, 0, v3
  v_mfma_f32_16x16x32_bf16 v[60:63], v[124:127], v[200:203], v[60:63]
  v_fma_f32 v237, v237, s63, -v156
  v_exp_f32 v236, v236
  v_mfma_f32_16x16x32_bf16 v[64:67], v[128:131], v[200:203], v[64:67]
  s_cbranch_vccnz LS_c5
LK_c5:
  ds_read_b64_tr_b16 v[100:101], v140 offset:57344
  ds_read_b64_tr_b16 v[102:103], v140 offset:61440
  ds_read_b64_tr_b16 v[104:105], v141 offset:57344
  ds_read_b64_tr_b16 v[106:107], v141 offset:61440
  v_fma_f32 v238, v238, s63, -v156
  v_mfma_f32_16x16x32_bf16 v[36:39], v[68:71], v[208:211], v[36:39]
  ds_read_b64_tr_b16 v[108:109], v142 offset:57344
  ds_read_b64_tr_b16 v[110:111], v142 offset:61440
  v_exp_f32 v237, v237
  v_mfma_f32_16x16x32_bf16 v[40:43], v[72:75], v[208:211], v[40:43]
  ds_read_b32 v3, v30 offset:432
  ds_read_b64_tr_b16 v[112:113], v143 offset:57344
  ds_read_b64_tr_b16 v[114:115], v143 offset:61440
  v_fma_f32 v239, v239, s63, -v156
  v_mfma_f32_16x16x32_bf16 v[44:47], v[76:79], v[208:211], v[44:47]
  s_waitcnt lgkmcnt(15)
  ds_read_b64_tr_b16 v[116:117], v144 offset:57344
  ds_read_b64_tr_b16 v[118:119], v144 offset:61440
  v_exp_f32 v238, v238
  v_mfma_f32_16x16x32_bf16 v[48:51], v[80:83], v[208:211], v[48:51]
  ds_read_b64_tr_b16 v[120:121], v145 offset:57344
  ds_read_b64_tr_b16 v[122:123], v145 offset:61440
  v_cvt_pk_bf16_f32 v232, v232, v233
  v_mfma_f32_16x16x32_bf16 v[52:55], v[84:87], v[208:211], v[52:55]
  ds_read_b64_tr_b16 v[124:125], v146 offset:57344
  ds_read_b64_tr_b16 v[126:127], v146 offset:61440
  v_exp_f32 v239, v239
  v_mfma_f32_16x16x32_bf16 v[56:59], v[88:91], v[208:211], v[56:59]
  ds_read_b64_tr_b16 v[128:129], v147 offset:57344
  ds_read_b64_tr_b16 v[130:131], v147 offset:61440
  s_waitcnt lgkmcnt(10)
  v_cmp_ne_u32 vcc, 0, v3
  v_mfma_f32_16x16x32_bf16 v[60:63], v[92:95], v[208:211], v[60:63]
  v_cvt_pk_bf16_f32 v233, v234, v235
  v_cvt_pk_bf16_f32 v234, v236, v237
  v_mfma_f32_16x16x32_bf16 v[64:67], v[96:99], v[208:211], v[64:67]
  s_cbranch_vccnz LS_c6
LK_c6:
  ds_read_b64_tr_b16 v[68:69], v18 offset:0
  ds_read_b64_tr_b16 v[70:71], v18 offset:4096
  ds_read_b64_tr_b16 v[72:73], v19 offset:0
  ds_read_b64_tr_b16 v[74:75], v19 offset:4096
  v_cvt_pk_bf16_f32 v235, v238, v239
  v_mfma_f32_16x16x32_bf16 v[36:39], v[100:103], v[216:219], v[36:39]
  ds_read_b64_tr_b16 v[76:77], v20 offset:0
  ds_read_b64_tr_b16 v[78:79], v20 offset:4096
  v_fma_f32 v240, v240, s63, -v156
  v_mfma_f32_16x16x32_bf16 v[40:43], v[104:107], v[216:219], v[40:43]
  ds_read_b64_tr_b16 v[80:81], v21 offset:0
  ds_read_b64_tr_b16 v[82:83], v21 offset:4096
  v_fma_f32 v241, v241, s63, -v156
  v_mfma_f32_16x16x32_bf16 v[132:135], v[148:151], v[232:235], v[132:135]
  ds_read_b64_tr_b16 v[84:85], v22 offset:0
  v_exp_f32 v240, v240
  v_mfma_f32_16x16x32_bf16 v[44:47], v[108:111], v[216:219], v[44:47]
  s_waitcnt lgkmcnt(15)
  ds_read_b64_tr_b16 v[86:87], v22 offset:4096
  v_fma_f32 v242, v242, s63, -v156
  v_mfma_f32_16x16x32_bf16 v[48:51], v[112:115], v[216:219], v[48:51]
  ds_read_b64_tr_b16 v[88:89], v23 offset:0
  ds_read_b64_tr_b16 v[90:91], v23 offset:4096
  v_exp_f32 v241, v241
  v_mfma_f32_16x16x32_bf16 v[52:55], v[116:119], v[216:219], v[52:55]
  s_waitcnt lgkmcnt(15)
  ds_read_b64_tr_b16 v[92:93], v24 offset:0
  ds_read_b64_tr_b16 v[94:95], v24 offset:4096
  v_fma_f32 v243, v243, s63, -v156
  v_mfma_f32_16x16x32_bf16 v[56:59], v[120:123], v[216:219], v[56:59]
  ds_read_b64_tr_b16 v[96:97], v25 offset:0
  ds_read_b64_tr_b16 v[98:99], v25 offset:4096
  v_exp_f32 v242, v242
  v_mfma_f32_16x16x32_bf16 v[60:63], v[124:127], v[216:219], v[60:63]
  s_waitcnt lgkmcnt(15)
  ds_read_b64_tr_b16 v[100:101], v18 offset:8192
  ds_read_b64_tr_b16 v[102:103], v18 offset:12288
  v_fma_f32 v244, v244, s63, -v156
  v_mfma_f32_16x16x32_bf16 v[64:67], v[128:131], v[216:219], v[64:67]
  ds_read_b64_tr_b16 v[104:105], v19 offset:8192
  ds_read_b64_tr_b16 v[106:107], v19 offset:12288
  v_exp_f32 v243, v243
  v_mfma_f32_16x16x32_bf16 v[36:39], v[68:71], v[224:227], v[36:39]
  s_waitcnt lgkmcnt(15)
  ds_read_b64_tr_b16 v[108:109], v20 offset:8192
  ds_read_b64_tr_b16 v[110:111], v20 offset:12288
  v_fma_f32 v245, v245, s63, -v156
  v_mfma_f32_16x16x32_bf16 v[40:43], v[72:75], v[224:227], v[40:43]
  ds_read_b32 v3, v30 offset:48
  ds_read_b64_tr_b16 v[112:113], v21 offset:8192
  ds_read_b64_tr_b16 v[114:115], v21 offset:12288
  v_exp_f32 v244, v244
  v_mfma_f32_16x16x32_bf16 v[44:47], v[76:79], v[224:227], v[44:47]
  s_waitcnt lgkmcnt(15)
  ds_read_b64_tr_b16 v[116:117], v22 offset:8192
  ds_read_b64_tr_b16 v[118:119], v22 offset:12288
  v_fma_f32 v246, v246, s63, -v156
  v_mfma_f32_16x16x32_bf16 v[48:51], v[80:83], v[224:227], v[48:51]
  ds_read_b64_tr_b16 v[120:121], v23 offset:8192
  ds_read_b64_tr_b16 v[122:123], v23 offset:12288
  v_exp_f32 v245, v245
  v_mfma_f32_16x16x32_bf16 v[52:55], v[84:87], v[224:227], v[52:55]
  ds_read_b64_tr_b16 v[124:125], v24 offset:8192
  ds_read_b64_tr_b16 v[126:127], v24 offset:12288
  v_fma_f32 v247, v247, s63, -v156
  v_mfma_f32_16x16x32_bf16 v[56:59], v[88:91], v[224:227], v[56:59]
  ds_read_b64_tr_b16 v[128:129], v25 offset:8192
  ds_read_b64_tr_b16 v[130:131], v25 offset:12288
  s_waitcnt lgkmcnt(10)
  v_cmp_ne_u32 vcc, 0, v3
  v_mfma_f32_16x16x32_bf16 v[60:63], v[92:95], v[224:227], v[60:63]
  v_exp_f32 v246, v246
  v_mfma_f32_16x16x32_bf16 v[64:67], v[96:99], v[224:227], v[64:67]
  s_cbranch_vccnz LS_c7
LK_c7:
  ds_read_b64_tr_b16 v[68:69], v18 offset:16384
  ds_read_b64_tr_b16 v[70:71], v18 offset:20480
  ds_read_b64_tr_b16 v[72:73], v19 offset:16384
  ds_read_b64_tr_b16 v[74:75], v19 offset:20480
  v_cvt_pk_bf16_f32 v240, v240, v241
  v_mfma_f32_16x16x32_bf16 v[36:39], v[100:103], v[232:235], v[36:39]
  ds_read_b64_tr_b16 v[76:77], v20 offset:16384
  ds_read_b64_tr_b16 v[78:79], v20 offset:20480
  v_exp_f32 v247, v247
  v_mfma_f32_16x16x32_bf16 v[40:43], v[104:107], v[232:235], v[40:43]
  ds_read_b64_tr_b16 v[80:81], v21 offset:16384
  ds_read_b64_tr_b16 v[82:83], v21 offset:20480
  v_cvt_pk_bf16_f32 v241, v242, v243
  v_mfma_f32_16x16x32_bf16 v[44:47], v[108:111], v[232:235], v[44:47]
  s_waitcnt lgkmcnt(15)
  ds_read_b64_tr_b16 v[84:85], v22 offset:16384
  ds_read_b64_tr_b16 v[86:87], v22 offset:20480
  v_cvt_pk_bf16_f32 v242, v244, v245
  v_mfma_f32_16x16x32_bf16 v[48:51], v[112:115], v[232:235], v[48:51]
  ds_read_b64_tr_b16 v[88:89], v23 offset:16384
  ds_read_b64_tr_b16 v[90:91], v23 offset:20480
  v_cvt_pk_bf16_f32 v243, v246, v247
  v_mfma_f32_16x16x32_bf16 v[52:55], v[116:119], v[232:235], v[52:55]
  s_waitcnt lgkmcnt(15)
  ds_read_b64_tr_b16 v[92:93], v24 offset:16384
  ds_read_b64_tr_b16 v[94:95], v24 offset:20480
  v_fma_f32 v248, v248, s63, -v156
  v_mfma_f32_16x16x32_bf16 v[56:59], v[120:123], v[232:235], v[56:59]
  ds_read_b64_tr_b16 v[96:97], v25 offset:16384
  ds_read_b64_tr_b16 v[98:99], v25 offset:20480
  v_fma_f32 v249, v249, s63, -v156
  v_mfma_f32_16x16x32_bf16 v[132:135], v[148:151], v[240:243], v[132:135]
  ds_add_u32 v32, v4
  v_exp_f32 v248, v248
  v_mfma_f32_16x16x32_bf16 v[60:63], v[124:127], v[232:235], v[60:63]
  ds_read_b64 v[152:153], v31
  ds_read_b64_tr_b16 v[100:101], v18 offset:24576
  ds_read_b64_tr_b16 v[102:103], v18 offset:28672
  v_fma_f32 v250, v250, s63, -v156
  s_waitcnt lgkmcnt(15)
  v_mfma_f32_16x16x32_bf16 v[64:67], v[128:131], v[232:235], v[64:67]
  ds_read_b64_tr_b16 v[104:105], v19 offset:24576
  ds_read_b64_tr_b16 v[106:107], v19 offset:28672
  v_exp_f32 v249, v249
  v_mfma_f32_16x16x32_bf16 v[36:39], v[68:71], v[240:243], v[36:39]
  ds_read_b64_tr_b16 v[108:109], v20 offset:24576
  ds_read_b64_tr_b16 v[110:111], v20 offset:28672
  v_fma_f32 v251, v251, s63, -v156
  v_mfma_f32_16x16x32_bf16 v[40:43], v[72:75], v[240:243], v[40:43]
  s_waitcnt lgkmcnt(15)
  ds_read_b64_tr_b16 v[112:113], v21 offset:24576
  ds_read_b64_tr_b16 v[114:115], v21 offset:28672
  v_exp_f32 v250, v250
  v_mfma_f32_16x16x32_bf16 v[44:47], v[76:79], v[240:243], v[44:47]
  ds_read_b64_tr_b16 v[116:117], v22 offset:24576
  ds_read_b64_tr_b16 v[118:119], v22 offset:28672
  s_waitcnt lgkmcnt(10)
  v_cmp_eq_u32 vcc, 0, v153
  v_mfma_f32_16x16x32_bf16 v[48:51], v[80:83], v[240:243], v[48:51]
  v_fma_f32 v252, v252, s63, -v156
  v_exp_f32 v251, v251
  v_mfma_f32_16x16x32_bf16 v[52:55], v[84:87], v[240:243], v[52:55]
  s_cbranch_vccnz LS_c8
LK_c8:
  ds_read_b64_tr_b16 v[120:121], v23 offset:24576
  ds_read_b64_tr_b16 v[122:123], v23 offset:28672
  ds_read_b64_tr_b16 v[124:125], v24 offset:24576
  ds_read_b64_tr_b16 v[126:127], v24 offset:28672
  v_fma_f32 v253, v253, s63, -v156
  v_mfma_f32_16x16x32_bf16 v[56:59], v[88:91], v[240:243], v[56:59]
  ds_read_b64_tr_b16 v[128:129], v25 offset:24576
  ds_read_b64_tr_b16 v[130:131], v25 offset:28672
  v_exp_f32 v252, v252
  v_mfma_f32_16x16x32_bf16 v[60:63], v[92:95], v[240:243], v[60:63]
  v_fma_f32 v254, v254, s63, -v156
  v_exp_f32 v253, v253
  v_mfma_f32_16x16x32_bf16 v[64:67], v[96:99], v[240:243], v[64:67]
  v_fma_f32 v255, v255, s63, -v156
  v_exp_f32 v254, v254
  v_cvt_pk_bf16_f32 v248, v248, v249
  v_exp_f32 v255, v255
  v_cvt_pk_bf16_f32 v249, v250, v251
  v_cvt_pk_bf16_f32 v250, v252, v253
  v_cvt_pk_bf16_f32 v251, v254, v255
  s_nop 1
  v_mfma_f32_16x16x32_bf16 v[132:135], v[148:151], v[248:251], v[132:135]
  s_waitcnt lgkmcnt(14)
  v_max_f32 v157, v156, v152
  v_sub_f32 v136, v156, v157
  v_mfma_f32_16x16x32_bf16 v[36:39], v[100:103], v[248:251], v[36:39]
  s_waitcnt lgkmcnt(12)
  v_sub_f32 v138, v152, v157
  v_exp_f32 v136, v136
  v_mfma_f32_16x16x32_bf16 v[40:43], v[104:107], v[248:251], v[40:43]
  s_waitcnt lgkmcnt(10)
  v_exp_f32 v138, v138
  v_mfma_f32_16x16x32_bf16 v[44:47], v[108:111], v[248:251], v[44:47]
  s_waitcnt lgkmcnt(8)
  v_mul_f32 v132, v136, v132
  v_fmac_f32 v132, v138, v153
  v_mfma_f32_16x16x32_bf16 v[48:51], v[112:115], v[248:251], v[48:51]
  s_waitcnt lgkmcnt(6)
  v_rcp_f32 v132, v132
  v_mfma_f32_16x16x32_bf16 v[52:55], v[116:119], v[248:251], v[52:55]
  s_waitcnt lgkmcnt(4)
  v_mul_f32 v138, v138, v132
  v_mul_f32 v136, v136, v132
  v_mfma_f32_16x16x32_bf16 v[56:59], v[120:123], v[248:251], v[56:59]
  ds_read_b32 v3, v32 offset:1280
  s_waitcnt lgkmcnt(3)
  v_mfma_f32_16x16x32_bf16 v[60:63], v[124:127], v[248:251], v[60:63]
  ds_read_b128 v[160:163], v34 offset:0
  s_waitcnt lgkmcnt(2)
  v_mfma_f32_16x16x32_bf16 v[64:67], v[128:131], v[248:251], v[64:67]
  ds_read_b128 v[164:167], v34 offset:1024
  ds_read_b128 v[168:171], v34 offset:2048
  ds_read_b128 v[172:175], v34 offset:3072
  ds_read_b128 v[176:179], v34 offset:4096
  ds_read_b128 v[180:183], v34 offset:5120
  ds_read_b128 v[184:187], v34 offset:6144
  ds_read_b128 v[188:191], v34 offset:7168
  v_pk_mul_f32 v[36:37], v[36:37], v[136:137] op_sel_hi:[1,0]
  v_pk_mul_f32 v[38:39], v[38:39], v[136:137] op_sel_hi:[1,0]
  v_pk_mul_f32 v[40:41], v[40:41], v[136:137] op_sel_hi:[1,0]
  s_waitcnt lgkmcnt(8)
  v_cmp_eq_u32 vcc, 0, v3
  v_pk_mul_f32 v[42:43], v[42:43], v[136:137] op_sel_hi:[1,0]
  v_pk_mul_f32 v[44:45], v[44:45], v[136:137] op_sel_hi:[1,0]
  v_pk_mul_f32 v[46:47], v[46:47], v[136:137] op_sel_hi:[1,0]
  v_pk_mul_f32 v[48:49], v[48:49], v[136:137] op_sel_hi:[1,0]
  v_pk_mul_f32 v[50:51], v[50:51], v[136:137] op_sel_hi:[1,0]
  v_pk_mul_f32 v[52:53], v[52:53], v[136:137] op_sel_hi:[1,0]
  s_cbranch_vccnz LS_c9
LK_c9:
  ds_add_u32 v32, v4
  v_pk_mul_f32 v[54:55], v[54:55], v[136:137] op_sel_hi:[1,0]
  v_pk_mul_f32 v[56:57], v[56:57], v[136:137] op_sel_hi:[1,0]
  v_pk_mul_f32 v[58:59], v[58:59], v[136:137] op_sel_hi:[1,0]
  v_pk_mul_f32 v[60:61], v[60:61], v[136:137] op_sel_hi:[1,0]
  v_pk_mul_f32 v[62:63], v[62:63], v[136:137] op_sel_hi:[1,0]
  v_pk_mul_f32 v[64:65], v[64:65], v[136:137] op_sel_hi:[1,0]
  v_pk_mul_f32 v[66:67], v[66:67], v[136:137] op_sel_hi:[1,0]
  s_waitcnt lgkmcnt(8)
  v_pk_fma_f32 v[160:161], v[160:161], v[138:139], v[36:37] op_sel_hi:[1,0,1]
  v_pk_fma_f32 v[162:163], v[162:163], v[138:139], v[38:39] op_sel_hi:[1,0,1]
  s_waitcnt lgkmcnt(7)
  v_pk_fma_f32 v[164:165], v[164:165], v[138:139], v[40:41] op_sel_hi:[1,0,1]
  v_pk_fma_f32 v[166:167], v[166:167], v[138:139], v[42:43] op_sel_hi:[1,0,1]
  v_cvt_pk_bf16_f32 v192, v160, v161
  v_cvt_pk_bf16_f32 v193, v162, v163
  v_cvt_pk_bf16_f32 v194, v164, v165
  v_cvt_pk_bf16_f32 v195, v166, v167
  s_waitcnt lgkmcnt(6)
  v_pk_fma_f32 v[168:169], v[168:169], v[138:139], v[44:45] op_sel_hi:[1,0,1]
  v_pk_fma_f32 v[170:171], v[170:171], v[138:139], v[46:47] op_sel_hi:[1,0,1]
  s_waitcnt lgkmcnt(5)
  v_pk_fma_f32 v[172:173], v[172:173], v[138:139], v[48:49] op_sel_hi:[1,0,1]
  v_pk_fma_f32 v[174:175], v[174:175], v[138:139], v[50:51] op_sel_hi:[1,0,1]
  v_cvt_pk_bf16_f32 v196, v168, v169
  v_cvt_pk_bf16_f32 v197, v170, v171
  v_cvt_pk_bf16_f32 v198, v172, v173
  v_cvt_pk_bf16_f32 v199, v174, v175
  s_waitcnt lgkmcnt(4)
  v_pk_fma_f32 v[176:177], v[176:177], v[138:139], v[52:53] op_sel_hi:[1,0,1]
  v_pk_fma_f32 v[178:179], v[178:179], v[138:139], v[54:55] op_sel_hi:[1,0,1]
  s_waitcnt lgkmcnt(3)
  v_pk_fma_f32 v[180:181], v[180:181], v[138:139], v[56:57] op_sel_hi:[1,0,1]
  v_pk_fma_f32 v[182:183], v[182:183], v[138:139], v[58:59] op_sel_hi:[1,0,1]
  v_cvt_pk_bf16_f32 v200, v176, v177
  v_cvt_pk_bf16_f32 v201, v178, v179
  v_cvt_pk_bf16_f32 v202, v180, v181
  v_cvt_pk_bf16_f32 v203, v182, v183
  s_waitcnt lgkmcnt(2)
  v_pk_fma_f32 v[184:185], v[184:185], v[138:139], v[60:61] op_sel_hi:[1,0,1]
  v_pk_fma_f32 v[186:187], v[186:187], v[138:139], v[62:63] op_sel_hi:[1,0,1]
  s_waitcnt lgkmcnt(1)
  v_pk_fma_f32 v[188:189], v[188:189], v[138:139], v[64:65] op_sel_hi:[1,0,1]
  v_pk_fma_f32 v[190:191], v[190:191], v[138:139], v[66:67] op_sel_hi:[1,0,1]
  v_cvt_pk_bf16_f32 v204, v184, v185
  v_cvt_pk_bf16_f32 v205, v186, v187
  v_cvt_pk_bf16_f32 v206, v188, v189
  v_cvt_pk_bf16_f32 v207, v190, v191
  buffer_store_dwordx4 v[192:195], v5, s[44:47], s60 offen offset:0 sc1
  buffer_store_dwordx4 v[196:199], v5, s[44:47], s60 offen offset:1024 sc1
  buffer_store_dwordx4 v[200:203], v5, s[44:47], s60 offen offset:2048 sc1
  buffer_store_dwordx4 v[204:207], v5, s[44:47], s60 offen offset:3072 sc1
  ds_add_u32 v32, v4
  v_lshlrev_b32 v9, 7, v0
  s_mov_b64 exec, 1
  s_waitcnt vmcnt(0)
  buffer_store_dword v4, v9, s[44:47], s62 offen sc1
L_noflag:
  s_mov_b64 exec, -1
  s_and_b32 s61, s54, 4
  s_cmp_lg_u32 s61, s58
  s_cbranch_scc1 L_nowarm
  s_mov_b32 exec_hi, 0
  buffer_load_dword v10, v9, s[44:47], s60 offen sc1
  s_mov_b64 exec, -1
L_nowarm:
L_ophase:
  v_lshlrev_b32 v12, 2, v0
  v_add_u32 v8, 40960, v5
  v_mov_b32 v9, 0
LW_c14:
  ds_read_b32 v3, v30 offset:64
  s_waitcnt lgkmcnt(0)
  v_cmp_ne_u32 vcc, 0, v3
  s_sub_u32 s99, s99, 1
  s_cbranch_scc1 L_end
  s_cbranch_vccnz LW_c14
  ds_read_b64_tr_b16 v[128:129], v26 offset:32768
  ds_read_b64_tr_b16 v[130:131], v26 offset:36864
  ds_read_b64_tr_b16 v[132:133], v27 offset:32768
  ds_read_b64_tr_b16 v[134:135], v27 offset:36864
  ds_read_b64_tr_b16 v[136:137], v26 offset:40960
  ds_read_b64_tr_b16 v[138:139], v26 offset:45056
  ds_read_b64_tr_b16 v[140:141], v27 offset:40960
  ds_read_b64_tr_b16 v[142:143], v27 offset:45056
  ds_read_b64_tr_b16 v[144:145], v26 offset:49152
  ds_read_b64_tr_b16 v[146:147], v26 offset:53248
  ds_read_b64_tr_b16 v[148:149], v27 offset:49152
  ds_read_b64_tr_b16 v[150:151], v27 offset:53248
  ds_read_b64_tr_b16 v[152:153], v26 offset:57344
  ds_read_b64_tr_b16 v[154:155], v26 offset:61440
  ds_read_b64_tr_b16 v[156:157], v27 offset:57344
  ds_read_b64_tr_b16 v[158:159], v27 offset:61440
  s_waitcnt lgkmcnt(0)
  s_mov_b64 exec, 1
  buffer_load_dword v5, s[20:23], 0 offen offset:272 lds
  s_mov_b64 exec, -1
LW_c15:
  ds_read_b32 v3, v30 offset:80
  s_waitcnt lgkmcnt(0)
  v_cmp_ne_u32 vcc, 0, v3
  s_sub_u32 s99, s99, 1
  s_cbranch_scc1 L_end
  s_cbranch_vccnz LW_c15
  ds_read_b64_tr_b16 v[160:161], v28 offset:0
  ds_read_b64_tr_b16 v[162:163], v28 offset:4096
  ds_read_b64_tr_b16 v[164:165], v29 offset:0
  ds_read_b64_tr_b16 v[166:167], v29 offset:4096
  ds_read_b64_tr_b16 v[168:169], v28 offset:8192
  ds_read_b64_tr_b16 v[170:171], v28 offset:12288
  ds_read_b64_tr_b16 v[172:173], v29 offset:8192
  ds_read_b64_tr_b16 v[174:175], v29 offset:12288
  ds_read_b64_tr_b16 v[176:177], v28 offset:16384
  ds_read_b64_tr_b16 v[178:179], v28 offset:20480
  ds_read_b64_tr_b16 v[180:181], v29 offset:16384
  ds_read_b64_tr_b16 v[182:183], v29 offset:20480
  ds_read_b64_tr_b16 v[184:185], v28 offset:24576
  ds_read_b64_tr_b16 v[186:187], v28 offset:28672
  ds_read_b64_tr_b16 v[188:189], v29 offset:24576
  ds_read_b64_tr_b16 v[190:191], v29 offset:28672
  s_waitcnt lgkmcnt(0)
LW_c16:
  ds_read_b32 v3, v30 offset:96
  s_waitcnt lgkmcnt(0)
  v_cmp_ne_u32 vcc, 0, v3
  s_sub_u32 s99, s99, 1
  s_cbranch_scc1 L_end
  s_cbranch_vccnz LW_c16
  ds_read_b64_tr_b16 v[192:193], v28 offset:32768
  ds_read_b64_tr_b16 v[194:195], v28 offset:36864
  ds_read_b64_tr_b16 v[196:197], v29 offset:32768
  ds_read_b64_tr_b16 v[198:199], v29 offset:36864
  ds_read_b64_tr_b16 v[200:201], v28 offset:40960
  ds_read_b64_tr_b16 v[202:203], v28 offset:45056
  ds_read_b64_tr_b16 v[204:205], v29 offset:40960
  ds_read_b64_tr_b16 v[206:207], v29 offset:45056
  ds_read_b64_tr_b16 v[208:209], v28 offset:49152
  ds_read_b64_tr_b16 v[210:211], v28 offset:53248
  ds_read_b64_tr_b16 v[212:213], v29 offset:49152
  ds_read_b64_tr_b16 v[214:215], v29 offset:53248
  ds_read_b64_tr_b16 v[216:217], v28 offset:57344
  ds_read_b64_tr_b16 v[218:219], v28 offset:61440
  ds_read_b64_tr_b16 v[220:221], v29 offset:57344
  ds_read_b64_tr_b16 v[222:223], v29 offset:61440
  s_waitcnt lgkmcnt(0)
  s_mov_b64 exec, 1
  buffer_load_dword v5, s[20:23], 0 offen offset:288 lds
  s_mov_b64 exec, -1
LW_c17:
  ds_read_b32 v3, v30 offset:144
  ds_read_b128 v[84:87], v33 offset:36864
  ds_read_b128 v[88:91], v33 offset:40960
  ds_read_b128 v[92:95], v33 offset:45056
  ds_read_b128 v[96:99], v33 offset:37888
  ds_read_b128 v[100:103], v33 offset:41984
  ds_read_b128 v[104:107], v33 offset:46080
  s_waitcnt lgkmcnt(6)
  v_cmp_ne_u32 vcc, 0, v3
  s_sub_u32 s99, s99, 1
  s_cbranch_scc1 L_end
  s_cbranch_vccnz LW_c17
  s_waitcnt lgkmcnt(5)
  v_mfma_f32_16x16x32_bf16 v[36:39], v[128:131], v[84:87], 0
  ds_read_b128 v[108:111], v33 offset:38912
  v_mfma_f32_16x16x32_bf16 v[40:43], v[132:135], v[84:87], 0
  ds_read_b128 v[112:115], v33 offset:43008
  s_waitcnt lgkmcnt(6)
  v_mfma_f32_16x16x32_bf16 v[44:47], v[128:131], v[88:91], 0
  ds_read_b128 v[116:119], v33 offset:47104
  v_mfma_f32_16x16x32_bf16 v[48:51], v[132:135], v[88:91], 0
  ds_read_b128 v[84:87], v33 offset:39936
  s_waitcnt lgkmcnt(7)
  v_mfma_f32_16x16x32_bf16 v[52:55], v[128:131], v[92:95], 0
  ds_read_b128 v[88:91], v33 offset:44032
  v_mfma_f32_16x16x32_bf16 v[56:59], v[132:135], v[92:95], 0
  ds_read_b128 v[92:95], v33 offset:48128
  s_waitcnt lgkmcnt(8)
  v_mfma_f32_16x16x32_bf16 v[36:39], v[136:139], v[96:99], v[36:39]
  v_mfma_f32_16x16x32_bf16 v[40:43], v[140:143], v[96:99], v[40:43]
  s_waitcnt lgkmcnt(7)
  v_mfma_f32_16x16x32_bf16 v[44:47], v[136:139], v[100:103], v[44:47]
  ds_read_b32 v3, v30 offset:160
  v_mfma_f32_16x16x32_bf16 v[48:51], v[140:143], v[100:103], v[48:51]
  s_waitcnt lgkmcnt(7)
  v_mfma_f32_16x16x32_bf16 v[52:55], v[136:139], v[104:107], v[52:55]
  v_mfma_f32_16x16x32_bf16 v[56:59], v[140:143], v[104:107], v[56:59]
  s_waitcnt lgkmcnt(6)
  v_mfma_f32_16x16x32_bf16 v[36:39], v[144:147], v[108:111], v[36:39]
  s_waitcnt lgkmcnt(0)
  v_cmp_ne_u32 vcc, 0, v3
  v_mfma_f32_16x16x32_bf16 v[40:43], v[148:151], v[108:111], v[40:43]
  v_mfma_f32_16x16x32_bf16 v[44:47], v[144:147], v[112:115], v[44:47]
  s_cbranch_vccnz LS_c18
LK_c18:
  ds_read_b128 v[96:99], v33 offset:49152
  v_mfma_f32_16x16x32_bf16 v[48:51], v[148:151], v[112:115], v[48:51]
  ds_read_b128 v[100:103], v33 offset:53248
  v_mfma_f32_16x16x32_bf16 v[52:55], v[144:147], v[116:119], v[52:55]
  ds_read_b128 v[104:107], v33 offset:57344
  v_mfma_f32_16x16x32_bf16 v[56:59], v[148:151], v[116:119], v[56:59]
  ds_read_b128 v[108:111], v33 offset:50176
  v_mfma_f32_16x16x32_bf16 v[36:39], v[152:155], v[84:87], v[36:39]
  ds_read_b128 v[112:115], v33 offset:54272
  v_mfma_f32_16x16x32_bf16 v[40:43], v[156:159], v[84:87], v[40:43]
  ds_read_b128 v[116:119], v33 offset:58368
  v_mfma_f32_16x16x32_bf16 v[44:47], v[152:155], v[88:91], v[44:47]
  ds_read_b128 v[84:87], v33 offset:51200
  v_mfma_f32_16x16x32_bf16 v[48:51], v[156:159], v[88:91], v[48:51]
  ds_read_b128 v[88:91], v33 offset:55296
  v_mfma_f32_16x16x32_bf16 v[52:55], v[152:155], v[92:95], v[52:55]
  v_mfma_f32_16x16x32_bf16 v[56:59], v[156:159], v[92:95], v[56:59]
  ds_read_b128 v[92:95], v33 offset:59392
  s_waitcnt lgkmcnt(8)
  v_mfma_f32_16x16x32_bf16 v[36:39], v[160:163], v[96:99], v[36:39]
  v_mfma_f32_16x16x32_bf16 v[40:43], v[164:167], v[96:99], v[40:43]
  ds_read_b128 v[96:99], v33 offset:52224
  s_waitcnt lgkmcnt(8)
  v_mfma_f32_16x16x32_bf16 v[44:47], v[160:163], v[100:103], v[44:47]
  v_mfma_f32_16x16x32_bf16 v[48:51], v[164:167], v[100:103], v[48:51]
  ds_read_b128 v[100:103], v33 offset:56320
  s_waitcnt lgkmcnt(8)
  v_mfma_f32_16x16x32_bf16 v[52:55], v[160:163], v[104:107], v[52:55]
  v_mfma_f32_16x16x32_bf16 v[56:59], v[164:167], v[104:107], v[56:59]
  ds_read_b128 v[104:107], v33 offset:60416
  s_waitcnt lgkmcnt(8)
  v_mfma_f32_16x16x32_bf16 v[36:39], v[168:171], v[108:111], v[36:39]
  v_mfma_f32_16x16x32_bf16 v[40:43], v[172:175], v[108:111], v[40:43]
  s_waitcnt lgkmcnt(7)
  v_mfma_f32_16x16x32_bf16 v[44:47], v[168:171], v[112:115], v[44:47]
  ds_read_b32 v3, v30 offset:176
  v_mfma_f32_16x16x32_bf16 v[48:51], v[172:175], v[112:115], v[48:51]
  s_waitcnt lgkmcnt(7)
  v_mfma_f32_16x16x32_bf16 v[52:55], v[168:171], v[116:119], v[52:55]
  v_mfma_f32_16x16x32_bf16 v[56:59], v[172:175], v[116:119], v[56:59]
  s_waitcnt lgkmcnt(6)
  v_mfma_f32_16x16x32_bf16 v[36:39], v[176:179], v[84:87], v[36:39]
  s_waitcnt lgkmcnt(0)
  v_cmp_ne_u32 vcc, 0, v3
  v_mfma_f32_16x16x32_bf16 v[40:43], v[180:183], v[84:87], v[40:43]
  v_mfma_f32_16x16x32_bf16 v[44:47], v[176:179], v[88:91], v[44:47]
  s_cbranch_vccnz LS_c19
LK_c19:
  ds_read_b128 v[108:111], v33 offset:0
  v_mfma_f32_16x16x32_bf16 v[48:51], v[180:183], v[88:91], v[48:51]
  ds_read_b128 v[112:115], v33 offset:4096
  v_mfma_f32_16x16x32_bf16 v[52:55], v[176:179], v[92:95], v[52:55]
  ds_read_b128 v[116:119], v33 offset:8192
  v_mfma_f32_16x16x32_bf16 v[56:59], v[180:183], v[92:95], v[56:59]
  ds_read_b128 v[84:87], v33 offset:1024
  v_mfma_f32_16x16x32_bf16 v[36:39], v[184:187], v[96:99], v[36:39]
  ds_read_b128 v[88:91], v33 offset:5120
  v_mfma_f32_16x16x32_bf16 v[40:43], v[188:191], v[96:99], v[40:43]
  ds_read_b128 v[92:95], v33 offset:9216
  v_mfma_f32_16x16x32_bf16 v[44:47], v[184:187], v[100:103], v[44:47]
  ds_read_b32 v3, v30 offset:112
  v_mfma_f32_16x16x32_bf16 v[48:51], v[188:191], v[100:103], v[48:51]
  ds_read_b128 v[96:99], v33 offset:2048
  v_mfma_f32_16x16x32_bf16 v[52:55], v[184:187], v[104:107], v[52:55]
  ds_read_b128 v[100:103], v33 offset:6144
  v_mfma_f32_16x16x32_bf16 v[56:59], v[188:191], v[104:107], v[56:59]
  ds_read_b128 v[104:107], v33 offset:10240
  s_waitcnt lgkmcnt(9)
  v_mfma_f32_16x16x32_bf16 v[36:39], v[192:195], v[108:111], v[36:39]
  s_waitcnt lgkmcnt(3)
  v_cmp_ne_u32 vcc, 0, v3
  v_mfma_f32_16x16x32_bf16 v[40:43], v[196:199], v[108:111], v[40:43]
  v_mfma_f32_16x16x32_bf16 v[44:47], v[192:195], v[112:115], v[44:47]
  s_cbranch_vccnz LS_c20
LK_c20:
  ds_read_b128 v[108:111], v33 offset:3072
  v_mfma_f32_16x16x32_bf16 v[48:51], v[196:199], v[112:115], v[48:51]
  ds_read_b128 v[112:115], v33 offset:7168
  v_mfma_f32_16x16x32_bf16 v[52:55], v[192:195], v[116:119], v[52:55]
  v_mfma_f32_16x16x32_bf16 v[56:59], v[196:199], v[116:119], v[56:59]
  ds_read_b128 v[116:119], v33 offset:11264
  v_mfma_f32_16x16x32_bf16 v[36:39], v[200:203], v[84:87], v[36:39]
  v_mfma_f32_16x16x32_bf16 v[40:43], v[204:207], v[84:87], v[40:43]
  v_mfma_f32_16x16x32_bf16 v[44:47], v[200:203], v[88:91], v[44:47]
  ds_read_b32 v3, v30 offset:192
  v_mfma_f32_16x16x32_bf16 v[48:51], v[204:207], v[88:91], v[48:51]
  v_mfma_f32_16x16x32_bf16 v[52:55], v[200:203], v[92:95], v[52:55]
  v_mfma_f32_16x16x32_bf16 v[56:59], v[204:207], v[92:95], v[56:59]
  s_waitcnt lgkmcnt(6)
  v_mfma_f32_16x16x32_bf16 v[36:39], v[208:211], v[96:99], v[36:39]
  s_waitcnt lgkmcnt(0)
  v_cmp_ne_u32 vcc, 0, v3
  v_mfma_f32_16x16x32_bf16 v[40:43], v[212:215], v[96:99], v[40:43]
  v_mfma_f32_16x16x32_bf16 v[44:47], v[208:211], v[100:103], v[44:47]
  s_cbranch_vccnz LS_c21
LK_c21:
  ds_read_b64_tr_b16 v[224:225], v26 offset:0
  ds_read_b64_tr_b16 v[226:227], v26 offset:4096
  ds_read_b128 v[84:87], v33 offset:12288
  v_mfma_f32_16x16x32_bf16 v[48:51], v[212:215], v[100:103], v[48:51]
  ds_read_b64_tr_b16 v[228:229], v27 offset:0
  ds_read_b64_tr_b16 v[230:231], v27 offset:4096
  v_mfma_f32_16x16x32_bf16 v[52:55], v[208:211], v[104:107], v[52:55]
  ds_read_b128 v[88:91], v33 offset:16384
  v_mfma_f32_16x16x32_bf16 v[56:59], v[212:215], v[104:107], v[56:59]
  ds_read_b128 v[92:95], v33 offset:20480
  v_mfma_f32_16x16x32_bf16 v[36:39], v[216:219], v[108:111], v[36:39]
  ds_read_b64_tr_b16 v[232:233], v26 offset:8192
  v_mfma_f32_16x16x32_bf16 v[40:43], v[220:223], v[108:111], v[40:43]
  ds_read_b64_tr_b16 v[234:235], v26 offset:12288
  v_mfma_f32_16x16x32_bf16 v[44:47], v[216:219], v[112:115], v[44:47]
  ds_read_b128 v[96:99], v33 offset:13312
  v_mfma_f32_16x16x32_bf16 v[48:51], v[220:223], v[112:115], v[48:51]
  ds_read_b64_tr_b16 v[236:237], v27 offset:8192
  ds_read_b64_tr_b16 v[238:239], v27 offset:12288
  v_mfma_f32_16x16x32_bf16 v[52:55], v[216:219], v[116:119], v[52:55]
  ds_read_b128 v[100:103], v33 offset:17408
  v_mfma_f32_16x16x32_bf16 v[56:59], v[220:223], v[116:119], v[56:59]
  ds_read_b128 v[104:107], v33 offset:21504
  s_waitcnt lgkmcnt(11)
  v_mfma_f32_16x16x32_bf16 v[36:39], v[224:227], v[84:87], v[36:39]
  ds_read_b64_tr_b16 v[240:241], v26 offset:16384
  s_waitcnt lgkmcnt(10)
  v_mfma_f32_16x16x32_bf16 v[40:43], v[228:231], v[84:87], v[40:43]
  ds_read_b64_tr_b16 v[242:243], v26 offset:20480
  s_waitcnt lgkmcnt(10)
  v_mfma_f32_16x16x32_bf16 v[44:47], v[224:227], v[88:91], v[44:47]
  ds_read_b128 v[108:111], v33 offset:14336
  v_mfma_f32_16x16x32_bf16 v[48:51], v[228:231], v[88:91], v[48:51]
  ds_read_b64_tr_b16 v[244:245], v27 offset:16384
  ds_read_b64_tr_b16 v[246:247], v27 offset:20480
  s_waitcnt lgkmcnt(12)
  v_mfma_f32_16x16x32_bf16 v[52:55], v[224:227], v[92:95], v[52:55]
  ds_read_b128 v[112:115], v33 offset:18432
  v_mfma_f32_16x16x32_bf16 v[56:59], v[228:231], v[92:95], v[56:59]
  ds_read_b128 v[116:119], v33 offset:22528
  s_waitcnt lgkmcnt(11)
  v_mfma_f32_16x16x32_bf16 v[36:39], v[232:235], v[96:99], v[36:39]
  ds_read_b64_tr_b16 v[248:249], v26 offset:24576
  s_waitcnt lgkmcnt(10)
  v_mfma_f32_16x16x32_bf16 v[40:43], v[236:239], v[96:99], v[40:43]
  ds_read_b64_tr_b16 v[250:251], v26 offset:28672
  s_waitcnt lgkmcnt(10)
  v_mfma_f32_16x16x32_bf16 v[44:47], v[232:235], v[100:103], v[44:47]
  ds_read_b128 v[84:87], v33 offset:15360
  v_mfma_f32_16x16x32_bf16 v[48:51], v[236:239], v[100:103], v[48:51]
  ds_read_b64_tr_b16 v[252:253], v27 offset:24576
  ds_read_b64_tr_b16 v[254:255], v27 offset:28672
  s_waitcnt lgkmcnt(12)
  v_mfma_f32_16x16x32_bf16 v[52:55], v[232:235], v[104:107], v[52:55]
  ds_read_b128 v[88:91], v33 offset:19456
  v_mfma_f32_16x16x32_bf16 v[56:59], v[236:239], v[104:107], v[56:59]
  ds_read_b128 v[92:95], v33 offset:23552
  s_waitcnt lgkmcnt(11)
  v_mfma_f32_16x16x32_bf16 v[36:39], v[240:243], v[108:111], v[36:39]
  ds_read_b32 v3, v30 offset:208
  s_waitcnt lgkmcnt(10)
  v_mfma_f32_16x16x32_bf16 v[40:43], v[244:247], v[108:111], v[40:43]
  s_waitcnt lgkmcnt(9)
  v_mfma_f32_16x16x32_bf16 v[44:47], v[240:243], v[112:115], v[44:47]
  v_mfma_f32_16x16x32_bf16 v[48:51], v[244:247], v[112:115], v[48:51]
  s_waitcnt lgkmcnt(8)
  v_mfma_f32_16x16x32_bf16 v[52:55], v[240:243], v[116:119], v[52:55]
  s_waitcnt lgkmcnt(0)
  v_cmp_ne_u32 vcc, 0, v3
  v_mfma_f32_16x16x32_bf16 v[56:59], v[244:247], v[116:119], v[56:59]
  v_mfma_f32_16x16x32_bf16 v[36:39], v[248:251], v[84:87], v[36:39]
  s_cbranch_vccnz LS_c22
LK_c22:
  ds_read_b128 v[96:99], v33 offset:24576
  ds_read_b128 v[100:103], v33 offset:28672
  ds_read_b128 v[104:107], v33 offset:32768
  v_mfma_f32_16x16x32_bf16 v[40:43], v[252:255], v[84:87], v[40:43]
  ds_read_b128 v[108:111], v33 offset:25600
  v_mfma_f32_16x16x32_bf16 v[44:47], v[248:251], v[88:91], v[44:47]
  ds_read_b128 v[112:115], v33 offset:29696
  v_max3_f32 v120, abs(v36), abs(v37), abs(v38)
  v_mfma_f32_16x16x32_bf16 v[48:51], v[252:255], v[88:91], v[48:51]
  ds_read_b128 v[116:119], v33 offset:33792
  v_mfma_f32_16x16x32_bf16 v[52:55], v[248:251], v[92:95], v[52:55]
  ds_read_b128 v[84:87], v33 offset:26624
  v_max3_f32 v121, abs(v39), abs(v40), abs(v41)
  v_mfma_f32_16x16x32_bf16 v[56:59], v[252:255], v[92:95], v[56:59]
  s_waitcnt lgkmcnt(6)
  ds_read_b128 v[88:91], v33 offset:30720
  v_max3_f32 v121, v121, abs(v42), abs(v43)
  v_mfma_f32_16x16x32_bf16 v[60:63], v[128:131], v[96:99], 0
  ds_read_b128 v[92:95], v33 offset:34816
  v_max3_f32 v120, v120, abs(v44), abs(v45)
  v_mfma_f32_16x16x32_bf16 v[64:67], v[132:135], v[96:99], 0
  s_waitcnt lgkmcnt(7)
  ds_read_b128 v[96:99], v33 offset:27648
  v_max3_f32 v121, v121, abs(v46), abs(v47)
  v_mfma_f32_16x16x32_bf16 v[68:71], v[128:131], v[100:103], 0
  v_max3_f32 v120, v120, abs(v48), abs(v49)
  v_max3_f32 v121, v121, abs(v50), abs(v51)
  v_mfma_f32_16x16x32_bf16 v[72:75], v[132:135], v[100:103], 0
  s_waitcnt lgkmcnt(7)
  ds_read_b128 v[100:103], v33 offset:31744
  v_max3_f32 v120, v120, abs(v52), abs(v53)
  v_mfma_f32_16x16x32_bf16 v[76:79], v[128:131], v[104:107], 0
  v_max3_f32 v121, v121, abs(v54), abs(v55)
  v_max3_f32 v120, v120, abs(v56), abs(v57)
  v_mfma_f32_16x16x32_bf16 v[80:83], v[132:135], v[104:107], 0
  s_waitcnt lgkmcnt(7)
  ds_read_b128 v[104:107], v33 offset:35840
  v_max3_f32 v121, v121, abs(v58), abs(v59)
  v_mfma_f32_16x16x32_bf16 v[60:63], v[136:139], v[108:111], v[60:63]
  v_max_f32 v120, v120, v121
  v_frexp_exp_i32_f32 v120, v120
  v_mfma_f32_16x16x32_bf16 v[64:67], v[140:143], v[108:111], v[64:67]
  s_waitcnt lgkmcnt(7)
  v_max_i32 v120, 0xffffff92, v120
  v_sub_u32 v122, 15, v120
  v_mfma_f32_16x16x32_bf16 v[68:71], v[136:139], v[112:115], v[68:71]
  ds_read_b32 v3, v30 offset:224
  v_add_u32 v121, -15, v120
  v_mfma_f32_16x16x32_bf16 v[72:75], v[140:143], v[112:115], v[72:75]
  s_waitcnt lgkmcnt(7)
  v_ldexp_f32 v122, 1.0, v122
  v_ldexp_f32 v121, 1.0, v121
  v_mfma_f32_16x16x32_bf16 v[76:79], v[136:139], v[116:119], v[76:79]
  v_mul_f32 v36, v122, v36
  v_mul_f32 v37, v122, v37
  v_mfma_f32_16x16x32_bf16 v[80:83], v[140:143], v[116:119], v[80:83]
  s_waitcnt lgkmcnt(6)
  v_mul_f32 v38, v122, v38
  v_mul_f32 v39, v122, v39
  v_mfma_f32_16x16x32_bf16 v[60:63], v[144:147], v[84:87], v[60:63]
  v_mul_f32 v40, v122, v40
  v_mul_f32 v41, v122, v41
  v_mfma_f32_16x16x32_bf16 v[64:67], v[148:151], v[84:87], v[64:67]
  s_waitcnt lgkmcnt(0)
  v_cmp_ne_u32 vcc, 0, v3
  v_mul_f32 v42, v122, v42
  v_mfma_f32_16x16x32_bf16 v[68:71], v[144:147], v[88:91], v[68:71]
  v_mul_f32 v43, v122, v43
  v_cvt_pk_f16_f32 v36, v36, v37
  v_mfma_f32_16x16x32_bf16 v[72:75], v[148:151], v[88:91], v[72:75]
  s_cbranch_vccnz LS_c23
LK_c23:
  ds_read_b128 v[108:111], v5 offset:0
  v_cvt_pk_f16_f32 v37, v38, v39
  v_mfma_f32_16x16x32_bf16 v[76:79], v[144:147], v[92:95], v[76:79]
  ds_read_b128 v[112:115], v5 offset:4096
  v_cvt_pk_f16_f32 v38, v40, v41
  v_mfma_f32_16x16x32_bf16 v[80:83], v[148:151], v[92:95], v[80:83]
  ds_read_b128 v[116:119], v5 offset:8192
  v_cvt_pk_f16_f32 v39, v42, v43
  v_mfma_f32_16x16x32_bf16 v[60:63], v[152:155], v[96:99], v[60:63]
  ds_read_b128 v[84:87], v5 offset:1024
  buffer_store_dword v121, v12, s[44:47], s4 offen offset:3072 sc1
  buffer_store_dwordx4 v[36:39], v5, s[44:47], s4 offen offset:0 sc1
  v_mul_f32 v44, v122, v44
  v_mfma_f32_16x16x32_bf16 v[64:67], v[156:159], v[96:99], v[64:67]
  ds_read_b128 v[88:91], v5 offset:5120
  v_mul_f32 v45, v122, v45
  v_mfma_f32_16x16x32_bf16 v[68:71], v[152:155], v[100:103], v[68:71]
  ds_read_b128 v[92:95], v5 offset:9216
  v_mul_f32 v46, v122, v46
  v_mfma_f32_16x16x32_bf16 v[72:75], v[156:159], v[100:103], v[72:75]
  ds_read_b128 v[96:99], v5 offset:2048
  v_mul_f32 v47, v122, v47
  v_mfma_f32_16x16x32_bf16 v[76:79], v[152:155], v[104:107], v[76:79]
  ds_read_b128 v[100:103], v5 offset:6144
  v_mul_f32 v48, v122, v48
  v_mfma_f32_16x16x32_bf16 v[80:83], v[156:159], v[104:107], v[80:83]
  s_waitcnt lgkmcnt(7)
  ds_read_b128 v[104:107], v5 offset:10240
  v_mul_f32 v49, v122, v49
  v_mfma_f32_16x16x32_bf16 v[60:63], v[160:163], v[108:111], v[60:63]
  v_mul_f32 v50, v122, v50
  v_mul_f32 v51, v122, v51
  v_mfma_f32_16x16x32_bf16 v[64:67], v[164:167], v[108:111], v[64:67]
  s_waitcnt lgkmcnt(7)
  ds_read_b128 v[108:111], v5 offset:3072
  v_cvt_pk_f16_f32 v44, v44, v45
  v_mfma_f32_16x16x32_bf16 v[68:71], v[160:163], v[112:115], v[68:71]
  v_cvt_pk_f16_f32 v45, v46, v47
  v_cvt_pk_f16_f32 v46, v48, v49
  v_mfma_f32_16x16x32_bf16 v[72:75], v[164:167], v[112:115], v[72:75]
  s_waitcnt lgkmcnt(7)
  ds_read_b128 v[112:115], v5 offset:7168
  v_cvt_pk_f16_f32 v47, v50, v51
  v_mfma_f32_16x16x32_bf16 v[76:79], v[160:163], v[116:119], v[76:79]
  buffer_store_dwordx4 v[44:47], v5, s[44:47], s4 offen offset:1024 sc1
  v_mul_f32 v52, v122, v52
  v_mfma_f32_16x16x32_bf16 v[80:83], v[164:167], v[116:119], v[80:83]
  s_waitcnt lgkmcnt(7)
  ds_read_b128 v[116:119], v5 offset:11264
  v_mul_f32 v53, v122, v53
  v_mfma_f32_16x16x32_bf16 v[60:63], v[168:171], v[84:87], v[60:63]
  v_mul_f32 v54, v122, v54
  v_mul_f32 v55, v122, v55
  v_mfma_f32_16x16x32_bf16 v[64:67], v[172:175], v[84:87], v[64:67]
  s_waitcnt lgkmcnt(7)
  v_mul_f32 v56, v122, v56
  v_mul_f32 v57, v122, v57
  v_mfma_f32_16x16x32_bf16 v[68:71], v[168:171], v[88:91], v[68:71]
  ds_read_b32 v3, v30 offset:240
  v_mul_f32 v58, v122, v58
  v_mfma_f32_16x16x32_bf16 v[72:75], v[172:175], v[88:91], v[72:75]
  s_waitcnt lgkmcnt(7)
  v_mul_f32 v59, v122, v59
  v_cvt_pk_f16_f32 v52, v52, v53
  v_mfma_f32_16x16x32_bf16 v[76:79], v[168:171], v[92:95], v[76:79]
  v_cvt_pk_f16_f32 v53, v54, v55
  v_cvt_pk_f16_f32 v54, v56, v57
  v_mfma_f32_16x16x32_bf16 v[80:83], v[172:175], v[92:95], v[80:83]
  s_waitcnt lgkmcnt(6)
  v_cvt_pk_f16_f32 v55, v58, v59
  v_mfma_f32_16x16x32_bf16 v[60:63], v[176:179], v[96:99], v[60:63]
  buffer_store_dwordx4 v[52:55], v5, s[44:47], s4 offen offset:2048 sc1
  s_waitcnt lgkmcnt(0)
  v_cmp_ne_u32 vcc, 0, v3
  v_mfma_f32_16x16x32_bf16 v[64:67], v[180:183], v[96:99], v[64:67]
  v_mfma_f32_16x16x32_bf16 v[68:71], v[176:179], v[100:103], v[68:71]
  s_cbranch_vccnz LS_c24
LK_c24:
  ds_read_b128 v[84:87], v5 offset:12288
  v_mfma_f32_16x16x32_bf16 v[72:75], v[180:183], v[100:103], v[72:75]
  ds_read_b128 v[88:91], v5 offset:16384
  v_mfma_f32_16x16x32_bf16 v[76:79], v[176:179], v[104:107], v[76:79]
  ds_read_b128 v[92:95], v5 offset:20480
  v_mfma_f32_16x16x32_bf16 v[80:83], v[180:183], v[104:107], v[80:83]
  ds_read_b128 v[96:99], v5 offset:13312
  v_mfma_f32_16x16x32_bf16 v[60:63], v[184:187], v[108:111], v[60:63]
  ds_read_b128 v[100:103], v5 offset:17408
  v_mfma_f32_16x16x32_bf16 v[64:67], v[188:191], v[108:111], v[64:67]
  ds_read_b128 v[104:107], v5 offset:21504
  v_mfma_f32_16x16x32_bf16 v[68:71], v[184:187], v[112:115], v[68:71]
  ds_read_b128 v[108:111], v5 offset:14336
  v_mfma_f32_16x16x32_bf16 v[72:75], v[188:191], v[112:115], v[72:75]
  ds_read_b128 v[112:115], v5 offset:18432
  v_mfma_f32_16x16x32_bf16 v[76:79], v[184:187], v[116:119], v[76:79]
  v_mfma_f32_16x16x32_bf16 v[80:83], v[188:191], v[116:119], v[80:83]
  ds_read_b128 v[116:119], v5 offset:22528
  s_waitcnt lgkmcnt(8)
  v_mfma_f32_16x16x32_bf16 v[60:63], v[192:195], v[84:87], v[60:63]
  v_mfma_f32_16x16x32_bf16 v[64:67], v[196:199], v[84:87], v[64:67]
  ds_read_b128 v[84:87], v5 offset:15360
  s_waitcnt lgkmcnt(8)
  v_mfma_f32_16x16x32_bf16 v[68:71], v[192:195], v[88:91], v[68:71]
  v_mfma_f32_16x16x32_bf16 v[72:75], v[196:199], v[88:91], v[72:75]
  ds_read_b128 v[88:91], v5 offset:19456
  s_waitcnt lgkmcnt(8)
  v_mfma_f32_16x16x32_bf16 v[76:79], v[192:195], v[92:95], v[76:79]
  v_mfma_f32_16x16x32_bf16 v[80:83], v[196:199], v[92:95], v[80:83]
  ds_read_b128 v[92:95], v5 offset:23552
  s_waitcnt lgkmcnt(8)
  v_mfma_f32_16x16x32_bf16 v[60:63], v[200:203], v[96:99], v[60:63]
  v_mfma_f32_16x16x32_bf16 v[64:67], v[204:207], v[96:99], v[64:67]
  s_waitcnt lgkmcnt(7)
  v_mfma_f32_16x16x32_bf16 v[68:71], v[200:203], v[100:103], v[68:71]
  ds_read_b32 v3, v30 offset:256
  v_mfma_f32_16x16x32_bf16 v[72:75], v[204:207], v[100:103], v[72:75]
  s_waitcnt lgkmcnt(7)
  v_mfma_f32_16x16x32_bf16 v[76:79], v[200:203], v[104:107], v[76:79]
  v_mfma_f32_16x16x32_bf16 v[80:83], v[204:207], v[104:107], v[80:83]
  s_waitcnt lgkmcnt(6)
  v_mfma_f32_16x16x32_bf16 v[60:63], v[208:211], v[108:111], v[60:63]
  s_waitcnt lgkmcnt(0)
  v_cmp_ne_u32 vcc, 0, v3
  v_mfma_f32_16x16x32_bf16 v[64:67], v[212:215], v[108:111], v[64:67]
  v_mfma_f32_16x16x32_bf16 v[68:71], v[208:211], v[112:115], v[68:71]
  s_cbranch_vccnz LS_c25
LK_c25:
  ds_read_b128 v[96:99], v5 offset:24576
  v_mfma_f32_16x16x32_bf16 v[72:75], v[212:215], v[112:115], v[72:75]
  ds_read_b128 v[100:103], v5 offset:28672
  v_mfma_f32_16x16x32_bf16 v[76:79], v[208:211], v[116:119], v[76:79]
  ds_read_b128 v[104:107], v5 offset:32768
  v_mfma_f32_16x16x32_bf16 v[80:83], v[212:215], v[116:119], v[80:83]
  ds_read_b128 v[108:111], v5 offset:25600
  v_mfma_f32_16x16x32_bf16 v[60:63], v[216:219], v[84:87], v[60:63]
  ds_read_b128 v[112:115], v5 offset:29696
  v_mfma_f32_16x16x32_bf16 v[64:67], v[220:223], v[84:87], v[64:67]
  ds_read_b128 v[116:119], v5 offset:33792
  v_mfma_f32_16x16x32_bf16 v[68:71], v[216:219], v[88:91], v[68:71]
  ds_read_b128 v[84:87], v5 offset:26624
  v_mfma_f32_16x16x32_bf16 v[72:75], v[220:223], v[88:91], v[72:75]
  ds_read_b128 v[88:91], v5 offset:30720
  v_mfma_f32_16x16x32_bf16 v[76:79], v[216:219], v[92:95], v[76:79]
  v_mfma_f32_16x16x32_bf16 v[80:83], v[220:223], v[92:95], v[80:83]
  ds_read_b128 v[92:95], v5 offset:34816
  s_waitcnt lgkmcnt(8)
  v_mfma_f32_16x16x32_bf16 v[60:63], v[224:227], v[96:99], v[60:63]
  v_mfma_f32_16x16x32_bf16 v[64:67], v[228:231], v[96:99], v[64:67]
  ds_read_b128 v[96:99], v5 offset:27648
  s_waitcnt lgkmcnt(8)
  v_mfma_f32_16x16x32_bf16 v[68:71], v[224:227], v[100:103], v[68:71]
  v_mfma_f32_16x16x32_bf16 v[72:75], v[228:231], v[100:103], v[72:75]
  ds_read_b128 v[100:103], v5 offset:31744
  s_waitcnt lgkmcnt(8)
  v_mfma_f32_16x16x32_bf16 v[76:79], v[224:227], v[104:107], v[76:79]
  v_mfma_f32_16x16x32_bf16 v[80:83], v[228:231], v[104:107], v[80:83]
  ds_read_b128 v[104:107], v5 offset:35840
  s_waitcnt lgkmcnt(8)
  v_mfma_f32_16x16x32_bf16 v[60:63], v[232:235], v[108:111], v[60:63]
  v_mfma_f32_16x16x32_bf16 v[64:67], v[236:239], v[108:111], v[64:67]
  s_waitcnt lgkmcnt(7)
  v_mfma_f32_16x16x32_bf16 v[68:71], v[232:235], v[112:115], v[68:71]
  v_mfma_f32_16x16x32_bf16 v[72:75], v[236:239], v[112:115], v[72:75]
  s_waitcnt lgkmcnt(6)
  v_mfma_f32_16x16x32_bf16 v[76:79], v[232:235], v[116:119], v[76:79]
  v_mfma_f32_16x16x32_bf16 v[80:83], v[236:239], v[116:119], v[80:83]
  s_waitcnt lgkmcnt(5)
  v_mfma_f32_16x16x32_bf16 v[60:63], v[240:243], v[84:87], v[60:63]
  v_mfma_f32_16x16x32_bf16 v[64:67], v[244:247], v[84:87], v[64:67]
  s_waitcnt lgkmcnt(4)
  v_mfma_f32_16x16x32_bf16 v[68:71], v[240:243], v[88:91], v[68:71]
  v_mfma_f32_16x16x32_bf16 v[72:75], v[244:247], v[88:91], v[72:75]
  s_waitcnt lgkmcnt(3)
  v_mfma_f32_16x16x32_bf16 v[76:79], v[240:243], v[92:95], v[76:79]
  v_mfma_f32_16x16x32_bf16 v[80:83], v[244:247], v[92:95], v[80:83]
  s_waitcnt vmcnt(0)
  s_mov_b64 exec, 1
  buffer_store_dword v4, v12, s[44:47], s5 offen sc1
  s_mov_b64 exec, -1
  s_waitcnt lgkmcnt(2)
  v_mfma_f32_16x16x32_bf16 v[60:63], v[248:251], v[96:99], v[60:63]
  v_mfma_f32_16x16x32_bf16 v[64:67], v[252:255], v[96:99], v[64:67]
  s_waitcnt lgkmcnt(1)
  v_mfma_f32_16x16x32_bf16 v[68:71], v[248:251], v[100:103], v[68:71]
  v_mfma_f32_16x16x32_bf16 v[72:75], v[252:255], v[100:103], v[72:75]
  s_waitcnt lgkmcnt(0)
  v_mfma_f32_16x16x32_bf16 v[76:79], v[248:251], v[104:107], v[76:79]
  v_mfma_f32_16x16x32_bf16 v[80:83], v[252:255], v[104:107], v[80:83]
  s_cmp_eq_u32 s3, s53
  s_cbranch_scc1 L_fin
  v_max3_f32 v120, abs(v60), abs(v61), abs(v62)
  v_max3_f32 v121, abs(v63), abs(v64), abs(v65)
  v_max3_f32 v121, v121, abs(v66), abs(v67)
  v_max3_f32 v120, v120, abs(v68), abs(v69)
  v_max3_f32 v121, v121, abs(v70), abs(v71)
  v_max3_f32 v120, v120, abs(v72), abs(v73)
  v_max3_f32 v121, v121, abs(v74), abs(v75)
  v_max3_f32 v120, v120, abs(v76), abs(v77)
  v_max3_f32 v121, v121, abs(v78), abs(v79)
  v_max3_f32 v120, v120, abs(v80), abs(v81)
  v_max3_f32 v121, v121, abs(v82), abs(v83)
  v_max_f32 v120, v120, v121
  v_frexp_exp_i32_f32 v120, v120
  v_max_i32 v120, 0xffffff92, v120
  v_sub_u32 v122, 15, v120
  v_add_u32 v121, -15, v120
  v_ldexp_f32 v122, 1.0, v122
  v_ldexp_f32 v121, 1.0, v121
  v_pk_mul_f32 v[60:61], v[60:61], v[122:123] op_sel_hi:[1,0]
  v_pk_mul_f32 v[62:63], v[62:63], v[122:123] op_sel_hi:[1,0]
  v_pk_mul_f32 v[64:65], v[64:65], v[122:123] op_sel_hi:[1,0]
  v_pk_mul_f32 v[66:67], v[66:67], v[122:123] op_sel_hi:[1,0]
  v_cvt_pk_f16_f32 v60, v60, v61
  v_cvt_pk_f16_f32 v61, v62, v63
  v_cvt_pk_f16_f32 v62, v64, v65
  v_cvt_pk_f16_f32 v63, v66, v67
  buffer_store_dword v121, v12, s[44:47], s8 offen offset:3072 sc1
  buffer_store_dwordx4 v[60:63], v5, s[44:47], s8 offen offset:0 sc1
  v_pk_mul_f32 v[68:69], v[68:69], v[122:123] op_sel_hi:[1,0]
  v_pk_mul_f32 v[70:71], v[70:71], v[122:123] op_sel_hi:[1,0]
  v_pk_mul_f32 v[72:73], v[72:73], v[122:123] op_sel_hi:[1,0]
  v_pk_mul_f32 v[74:75], v[74:75], v[122:123] op_sel_hi:[1,0]
  v_cvt_pk_f16_f32 v68, v68, v69
  v_cvt_pk_f16_f32 v69, v70, v71
  v_cvt_pk_f16_f32 v70, v72, v73
  v_cvt_pk_f16_f32 v71, v74, v75
  buffer_store_dwordx4 v[68:71], v5, s[44:47], s8 offen offset:1024 sc1
  v_pk_mul_f32 v[76:77], v[76:77], v[122:123] op_sel_hi:[1,0]
  v_pk_mul_f32 v[78:79], v[78:79], v[122:123] op_sel_hi:[1,0]
  v_pk_mul_f32 v[80:81], v[80:81], v[122:123] op_sel_hi:[1,0]
  v_pk_mul_f32 v[82:83], v[82:83], v[122:123] op_sel_hi:[1,0]
  v_cvt_pk_f16_f32 v76, v76, v77
  v_cvt_pk_f16_f32 v77, v78, v79
  v_cvt_pk_f16_f32 v78, v80, v81
  v_cvt_pk_f16_f32 v79, v82, v83
  buffer_store_dwordx4 v[76:79], v5, s[44:47], s8 offen offset:2048 sc1
  s_waitcnt vmcnt(0)
  s_mov_b64 exec, 1
  buffer_store_dword v4, v12, s[44:47], s9 offen sc1
  s_mov_b64 exec, -1
  s_endpgm
L_fin:
  s_nop 3
  ds_write_b128 v8, v[60:63] offset:0
  ds_write_b128 v8, v[64:67] offset:1024
  ds_write_b128 v8, v[68:71] offset:2048
  ds_write_b128 v8, v[72:75] offset:3072
  ds_write_b128 v8, v[76:79] offset:4096
  ds_write_b128 v8, v[80:83] offset:5120
  s_mov_b64 exec, 15
  ds_write_b32 v30, v9 offset:320
  s_mov_b64 exec, -1
  s_waitcnt vmcnt(0) lgkmcnt(0)
  s_endpgm
L_w3:
  s_waitcnt lgkmcnt(0)
  s_barrier
  ds_read_b128 v[84:87], v14 offset:57344
  ds_read_b128 v[36:39], v2 offset:0
  ds_read_b128 v[52:55], v2 offset:4096
  ds_read_b128 v[68:71], v2 offset:8192
  ds_read_b128 v[88:91], v15 offset:57344
  ds_read_b128 v[40:43], v2 offset:1024
  ds_read_b128 v[56:59], v2 offset:5120
  ds_read_b128 v[72:75], v2 offset:9216
  ds_read_b128 v[92:95], v16 offset:57344
  ds_read_b128 v[44:47], v2 offset:2048
  ds_read_b128 v[60:63], v2 offset:6144
  s_waitcnt lgkmcnt(9)
  v_mfma_f32_16x16x32_bf16 v[160:163], v[84:87], v[36:39], 0
  ds_read_b128 v[76:79], v2 offset:10240
  s_waitcnt lgkmcnt(9)
  v_mfma_f32_16x16x32_bf16 v[164:167], v[84:87], v[52:55], 0
  ds_read_b128 v[96:99], v17 offset:57344
  s_waitcnt lgkmcnt(9)
  v_mfma_f32_16x16x32_bf16 v[168:171], v[84:87], v[68:71], 0
  ds_read_b128 v[48:51], v2 offset:3072
  ds_read_b128 v[64:67], v2 offset:7168
  s_waitcnt lgkmcnt(9)
  v_mfma_f32_16x16x32_bf16 v[160:163], v[88:91], v[40:43], v[160:163]
  ds_read_b128 v[80:83], v2 offset:11264
  s_waitcnt lgkmcnt(9)
  v_mfma_f32_16x16x32_bf16 v[164:167], v[88:91], v[56:59], v[164:167]
  ds_read_b128 v[100:103], v14 offset:61440
  s_waitcnt lgkmcnt(9)
  v_mfma_f32_16x16x32_bf16 v[168:171], v[88:91], v[72:75], v[168:171]
  ds_read_b128 v[104:107], v15 offset:61440
  ds_read_b128 v[108:111], v16 offset:61440
  s_waitcnt lgkmcnt(9)
  v_mfma_f32_16x16x32_bf16 v[160:163], v[92:95], v[44:47], v[160:163]
  ds_read_b128 v[112:115], v17 offset:61440
  s_waitcnt lgkmcnt(9)
  v_mfma_f32_16x16x32_bf16 v[164:167], v[92:95], v[60:63], v[164:167]
  s_waitcnt lgkmcnt(8)
  v_mfma_f32_16x16x32_bf16 v[168:171], v[92:95], v[76:79], v[168:171]
  s_waitcnt lgkmcnt(6)
  v_mfma_f32_16x16x32_bf16 v[160:163], v[96:99], v[48:51], v[160:163]
  s_waitcnt lgkmcnt(5)
  v_mfma_f32_16x16x32_bf16 v[164:167], v[96:99], v[64:67], v[164:167]
  s_waitcnt lgkmcnt(4)
  v_mfma_f32_16x16x32_bf16 v[168:171], v[96:99], v[80:83], v[168:171]
  s_waitcnt lgkmcnt(3)
  v_mfma_f32_16x16x32_bf16 v[172:175], v[100:103], v[36:39], 0
  v_mfma_f32_16x16x32_bf16 v[176:179], v[100:103], v[52:55], 0
  v_mfma_f32_16x16x32_bf16 v[180:183], v[100:103], v[68:71], 0
  s_waitcnt lgkmcnt(0)
  v_mfma_f32_16x16x32_bf16 v[172:175], v[104:107], v[40:43], v[172:175]
  v_max_f32 v156, v160, v161
  v_mfma_f32_16x16x32_bf16 v[176:179], v[104:107], v[56:59], v[176:179]
  s_barrier
  ds_read_b128 v[116:119], v8 offset:24576
  v_max_f32 v157, v164, v165
  v_mfma_f32_16x16x32_bf16 v[180:183], v[104:107], v[72:75], v[180:183]
  ds_read_b128 v[120:123], v9 offset:24576
  v_max_f32 v158, v168, v169
  v_mfma_f32_16x16x32_bf16 v[172:175], v[108:111], v[44:47], v[172:175]
  ds_read_b128 v[124:127], v10 offset:24576
  v_max3_f32 v156, v156, v162, v163
  v_mfma_f32_16x16x32_bf16 v[176:179], v[108:111], v[60:63], v[176:179]
  ds_read_b128 v[128:131], v11 offset:24576
  v_max3_f32 v157, v157, v166, v167
  v_mfma_f32_16x16x32_bf16 v[180:183], v[108:111], v[76:79], v[180:183]
  ds_read_b128 v[84:87], v8 offset:28672
  v_max3_f32 v158, v158, v170, v171
  v_mfma_f32_16x16x32_bf16 v[172:175], v[112:115], v[48:51], v[172:175]
  ds_read_b128 v[88:91], v9 offset:28672
  v_mfma_f32_16x16x32_bf16 v[176:179], v[112:115], v[64:67], v[176:179]
  ds_read_b128 v[92:95], v10 offset:28672
  v_mfma_f32_16x16x32_bf16 v[180:183], v[112:115], v[80:83], v[180:183]
  ds_read_b128 v[96:99], v11 offset:28672
  s_waitcnt lgkmcnt(7)
  v_mfma_f32_16x16x32_bf16 v[184:187], v[116:119], v[36:39], 0
  s_nop 0
  v_max3_f32 v156, v156, v172, v173
  v_mfma_f32_16x16x32_bf16 v[188:191], v[116:119], v[52:55], 0
  v_max3_f32 v157, v157, v176, v177
  v_mfma_f32_16x16x32_bf16 v[192:195], v[116:119], v[68:71], 0
  s_waitcnt lgkmcnt(6)
  v_max3_f32 v158, v158, v180, v181
  v_mfma_f32_16x16x32_bf16 v[184:187], v[120:123], v[40:43], v[184:187]
  v_max3_f32 v156, v156, v174, v175
  v_max3_f32 v157, v157, v178, v179
  v_mfma_f32_16x16x32_bf16 v[188:191], v[120:123], v[56:59], v[188:191]
  s_waitcnt lgkmcnt(0)
  v_max3_f32 v158, v158, v182, v183
  v_mfma_f32_16x16x32_bf16 v[192:195], v[120:123], v[72:75], v[192:195]
  v_mfma_f32_16x16x32_bf16 v[184:187], v[124:127], v[44:47], v[184:187]
  v_mfma_f32_16x16x32_bf16 v[188:191], v[124:127], v[60:63], v[188:191]
  v_mfma_f32_16x16x32_bf16 v[192:195], v[124:127], v[76:79], v[192:195]
  v_mfma_f32_16x16x32_bf16 v[184:187], v[128:131], v[48:51], v[184:187]
  v_mfma_f32_16x16x32_bf16 v[188:191], v[128:131], v[64:67], v[188:191]
  v_mfma_f32_16x16x32_bf16 v[192:195], v[128:131], v[80:83], v[192:195]
  v_mfma_f32_16x16x32_bf16 v[196:199], v[84:87], v[36:39], 0
  v_mfma_f32_16x16x32_bf16 v[200:203], v[84:87], v[52:55], 0
  v_mfma_f32_16x16x32_bf16 v[204:207], v[84:87], v[68:71], 0
  s_nop 2
  v_max3_f32 v156, v156, v184, v185
  v_mfma_f32_16x16x32_bf16 v[196:199], v[88:91], v[40:43], v[196:199]
  v_max3_f32 v157, v157, v188, v189
  v_mfma_f32_16x16x32_bf16 v[200:203], v[88:91], v[56:59], v[200:203]
  s_barrier
  ds_read_b128 v[100:103], v8 offset:57344
  v_max3_f32 v158, v158, v192, v193
  v_mfma_f32_16x16x32_bf16 v[204:207], v[88:91], v[72:75], v[204:207]
  ds_read_b128 v[104:107], v9 offset:57344
  v_max3_f32 v156, v156, v186, v187
  v_mfma_f32_16x16x32_bf16 v[196:199], v[92:95], v[44:47], v[196:199]
  ds_read_b128 v[108:111], v10 offset:57344
  v_max3_f32 v157, v157, v190, v191
  v_mfma_f32_16x16x32_bf16 v[200:203], v[92:95], v[60:63], v[200:203]
  ds_read_b128 v[112:115], v11 offset:57344
  v_max3_f32 v158, v158, v194, v195
  v_mfma_f32_16x16x32_bf16 v[204:207], v[92:95], v[76:79], v[204:207]
  ds_read_b128 v[116:119], v8 offset:61440
  v_mfma_f32_16x16x32_bf16 v[196:199], v[96:99], v[48:51], v[196:199]
  ds_read_b128 v[120:123], v9 offset:61440
  v_mfma_f32_16x16x32_bf16 v[200:203], v[96:99], v[64:67], v[200:203]
  ds_read_b128 v[124:127], v10 offset:61440
  v_mfma_f32_16x16x32_bf16 v[204:207], v[96:99], v[80:83], v[204:207]
  ds_read_b128 v[128:131], v11 offset:61440
  s_waitcnt lgkmcnt(7)
  v_mfma_f32_16x16x32_bf16 v[208:211], v[100:103], v[36:39], 0
  s_nop 0
  v_max3_f32 v156, v156, v196, v197
  v_mfma_f32_16x16x32_bf16 v[212:215], v[100:103], v[52:55], 0
  v_max3_f32 v157, v157, v200, v201
  v_mfma_f32_16x16x32_bf16 v[216:219], v[100:103], v[68:71], 0
  s_waitcnt lgkmcnt(6)
  v_max3_f32 v158, v158, v204, v205
  v_mfma_f32_16x16x32_bf16 v[208:211], v[104:107], v[40:43], v[208:211]
  v_max3_f32 v156, v156, v198, v199
  v_max3_f32 v157, v157, v202, v203
  v_mfma_f32_16x16x32_bf16 v[212:215], v[104:107], v[56:59], v[212:215]
  s_waitcnt lgkmcnt(0)
  v_max3_f32 v158, v158, v206, v207
  v_mfma_f32_16x16x32_bf16 v[216:219], v[104:107], v[72:75], v[216:219]
  v_mfma_f32_16x16x32_bf16 v[208:211], v[108:111], v[44:47], v[208:211]
  v_mfma_f32_16x16x32_bf16 v[212:215], v[108:111], v[60:63], v[212:215]
  v_mfma_f32_16x16x32_bf16 v[216:219], v[108:111], v[76:79], v[216:219]
  v_mfma_f32_16x16x32_bf16 v[208:211], v[112:115], v[48:51], v[208:211]
  v_mfma_f32_16x16x32_bf16 v[212:215], v[112:115], v[64:67], v[212:215]
  v_mfma_f32_16x16x32_bf16 v[216:219], v[112:115], v[80:83], v[216:219]
  v_mfma_f32_16x16x32_bf16 v[220:223], v[116:119], v[36:39], 0
  v_mfma_f32_16x16x32_bf16 v[224:227], v[116:119], v[52:55], 0
  v_mfma_f32_16x16x32_bf16 v[228:231], v[116:119], v[68:71], 0
  s_nop 2
  v_max3_f32 v156, v156, v208, v209
  v_mfma_f32_16x16x32_bf16 v[220:223], v[120:123], v[40:43], v[220:223]
  v_max3_f32 v157, v157, v212, v213
  v_mfma_f32_16x16x32_bf16 v[224:227], v[120:123], v[56:59], v[224:227]
  s_barrier
  ds_read_b128 v[84:87], v14 offset:24576
  v_max3_f32 v158, v158, v216, v217
  v_mfma_f32_16x16x32_bf16 v[228:231], v[120:123], v[72:75], v[228:231]
  ds_read_b128 v[88:91], v15 offset:24576
  v_max3_f32 v156, v156, v210, v211
  v_mfma_f32_16x16x32_bf16 v[220:223], v[124:127], v[44:47], v[220:223]
  ds_read_b128 v[92:95], v16 offset:24576
  v_max3_f32 v157, v157, v214, v215
  v_mfma_f32_16x16x32_bf16 v[224:227], v[124:127], v[60:63], v[224:227]
  ds_read_b128 v[96:99], v17 offset:24576
  v_max3_f32 v158, v158, v218, v219
  v_mfma_f32_16x16x32_bf16 v[228:231], v[124:127], v[76:79], v[228:231]
  ds_read_b128 v[100:103], v14 offset:28672
  v_mfma_f32_16x16x32_bf16 v[220:223], v[128:131], v[48:51], v[220:223]
  ds_read_b128 v[104:107], v15 offset:28672
  v_mfma_f32_16x16x32_bf16 v[224:227], v[128:131], v[64:67], v[224:227]
  ds_read_b128 v[108:111], v16 offset:28672
  v_mfma_f32_16x16x32_bf16 v[228:231], v[128:131], v[80:83], v[228:231]
  ds_read_b128 v[112:115], v17 offset:28672
  s_waitcnt lgkmcnt(7)
  v_mfma_f32_16x16x32_bf16 v[232:235], v[84:87], v[36:39], 0
  ds_add_u32 v32, v4
  v_mfma_f32_16x16x32_bf16 v[236:239], v[84:87], v[52:55], 0
  v_max3_f32 v156, v156, v220, v221
  v_mfma_f32_16x16x32_bf16 v[240:243], v[84:87], v[68:71], 0
  s_waitcnt lgkmcnt(7)
  v_max3_f32 v157, v157, v224, v225
  v_mfma_f32_16x16x32_bf16 v[232:235], v[88:91], v[40:43], v[232:235]
  v_max3_f32 v158, v158, v228, v229
  v_max3_f32 v156, v156, v222, v223
  v_mfma_f32_16x16x32_bf16 v[236:239], v[88:91], v[56:59], v[236:239]
  v_max3_f32 v157, v157, v226, v227
  v_max3_f32 v158, v158, v230, v231
  v_mfma_f32_16x16x32_bf16 v[240:243], v[88:91], v[72:75], v[240:243]
  s_waitcnt lgkmcnt(6)
  v_mfma_f32_16x16x32_bf16 v[232:235], v[92:95], v[44:47], v[232:235]
  v_mfma_f32_16x16x32_bf16 v[236:239], v[92:95], v[60:63], v[236:239]
  v_mfma_f32_16x16x32_bf16 v[240:243], v[92:95], v[76:79], v[240:243]
  s_waitcnt lgkmcnt(5)
  v_mfma_f32_16x16x32_bf16 v[232:235], v[96:99], v[48:51], v[232:235]
  v_mfma_f32_16x16x32_bf16 v[236:239], v[96:99], v[64:67], v[236:239]
  v_mfma_f32_16x16x32_bf16 v[240:243], v[96:99], v[80:83], v[240:243]
  s_waitcnt lgkmcnt(4)
  v_mfma_f32_16x16x32_bf16 v[244:247], v[100:103], v[36:39], 0
  v_mfma_f32_16x16x32_bf16 v[248:251], v[100:103], v[52:55], 0
  v_mfma_f32_16x16x32_bf16 v[252:255], v[100:103], v[68:71], 0
  s_nop 1
  v_max3_f32 v156, v156, v232, v233
  s_waitcnt lgkmcnt(3)
  v_mfma_f32_16x16x32_bf16 v[244:247], v[104:107], v[40:43], v[244:247]
  v_max3_f32 v157, v157, v236, v237
  v_mfma_f32_16x16x32_bf16 v[248:251], v[104:107], v[56:59], v[248:251]
  v_max3_f32 v158, v158, v240, v241
  v_max3_f32 v156, v156, v234, v235
  v_mfma_f32_16x16x32_bf16 v[252:255], v[104:107], v[72:75], v[252:255]
  s_waitcnt lgkmcnt(2)
  v_max3_f32 v157, v157, v238, v239
  v_max3_f32 v158, v158, v242, v243
  v_mfma_f32_16x16x32_bf16 v[244:247], v[108:111], v[44:47], v[244:247]
  v_mfma_f32_16x16x32_bf16 v[248:251], v[108:111], v[60:63], v[248:251]
  v_mfma_f32_16x16x32_bf16 v[252:255], v[108:111], v[76:79], v[252:255]
  s_waitcnt lgkmcnt(1)
  v_mfma_f32_16x16x32_bf16 v[244:247], v[112:115], v[48:51], v[244:247]
  v_mfma_f32_16x16x32_bf16 v[248:251], v[112:115], v[64:67], v[248:251]
  v_mfma_f32_16x16x32_bf16 v[252:255], v[112:115], v[80:83], v[252:255]
  s_nop 5
  v_max3_f32 v156, v156, v244, v245
  v_max3_f32 v157, v157, v248, v249
  v_max3_f32 v158, v158, v252, v253
  v_max3_f32 v156, v156, v246, v247
  v_max3_f32 v157, v157, v250, v251
  v_max3_f32 v158, v158, v254, v255
  v_mov_b32 v152, v156
  v_mov_b32 v153, v157
  v_mov_b32 v154, v158
  v_permlane32_swap_b32 v152, v156
  v_permlane32_swap_b32 v153, v157
  v_permlane32_swap_b32 v154, v158
  v_max_f32 v156, v156, v152
  v_max_f32 v157, v157, v153
  v_max_f32 v158, v158, v154
  v_mov_b32 v152, v156
  v_mov_b32 v153, v157
  v_mov_b32 v154, v158
  v_permlane16_swap_b32 v152, v156
  v_permlane16_swap_b32 v153, v157
  v_permlane16_swap_b32 v154, v158
  v_max_f32 v156, v156, v152
  v_max_f32 v157, v157, v153
  v_max_f32 v158, v158, v154
  v_mul_f32 v156, s63, v156
  v_mul_f32 v157, s63, v157
  v_mul_f32 v158, s63, v158
  v_fma_f32 v160, v160, s63, -v156
  v_fma_f32 v161, v161, s63, -v156
  v_exp_f32 v160, v160
  v_fma_f32 v162, v162, s63, -v156
  v_exp_f32 v161, v161
  v_fma_f32 v163, v163, s63, -v156
  v_exp_f32 v162, v162
  v_fma_f32 v172, v172, s63, -v156
  v_exp_f32 v163, v163
  v_fma_f32 v173, v173, s63, -v156
  v_exp_f32 v172, v172
  v_fma_f32 v174, v174, s63, -v156
  v_exp_f32 v173, v173
  v_fma_f32 v175, v175, s63, -v156
  v_exp_f32 v174, v174
  v_cvt_pk_bf16_f32 v160, v160, v161
  v_exp_f32 v175, v175
  v_cvt_pk_bf16_f32 v161, v162, v163
  v_cvt_pk_bf16_f32 v162, v172, v173
  v_cvt_pk_bf16_f32 v163, v174, v175
  v_fma_f32 v164, v164, s63, -v157
  v_fma_f32 v165, v165, s63, -v157
  v_mfma_f32_16x16x32_bf16 v[172:175], v[148:151], v[160:163], 0
  v_exp_f32 v164, v164
  v_fma_f32 v166, v166, s63, -v157
  v_exp_f32 v165, v165
  v_fma_f32 v167, v167, s63, -v157
  v_exp_f32 v166, v166
  v_fma_f32 v176, v176, s63, -v157
  v_exp_f32 v167, v167
  v_fma_f32 v177, v177, s63, -v157
  v_exp_f32 v176, v176
  v_fma_f32 v178, v178, s63, -v157
  v_exp_f32 v177, v177
  v_fma_f32 v179, v179, s63, -v157
  v_exp_f32 v178, v178
  v_cvt_pk_bf16_f32 v164, v164, v165
  v_exp_f32 v179, v179
  v_cvt_pk_bf16_f32 v165, v166, v167
  v_cvt_pk_bf16_f32 v166, v176, v177
  v_cvt_pk_bf16_f32 v167, v178, v179
  v_fma_f32 v168, v168, s63, -v158
  v_fma_f32 v169, v169, s63, -v158
  v_mfma_f32_16x16x32_bf16 v[176:179], v[148:151], v[164:167], 0
  v_exp_f32 v168, v168
  v_fma_f32 v170, v170, s63, -v158
  v_exp_f32 v169, v169
  v_fma_f32 v171, v171, s63, -v158
  v_exp_f32 v170, v170
  v_fma_f32 v180, v180, s63, -v158
  v_exp_f32 v171, v171
  v_fma_f32 v181, v181, s63, -v158
  v_exp_f32 v180, v180
  v_fma_f32 v182, v182, s63, -v158
  v_exp_f32 v181, v181
  v_fma_f32 v183, v183, s63, -v158
  v_exp_f32 v182, v182
  v_cvt_pk_bf16_f32 v168, v168, v169
  v_exp_f32 v183, v183
  v_cvt_pk_bf16_f32 v169, v170, v171
  v_cvt_pk_bf16_f32 v170, v180, v181
  v_cvt_pk_bf16_f32 v171, v182, v183
  v_fma_f32 v184, v184, s63, -v156
  v_fma_f32 v185, v185, s63, -v156
  v_mfma_f32_16x16x32_bf16 v[180:183], v[148:151], v[168:171], 0
  v_exp_f32 v184, v184
  v_fma_f32 v186, v186, s63, -v156
  v_exp_f32 v185, v185
  v_fma_f32 v187, v187, s63, -v156
  v_exp_f32 v186, v186
  v_fma_f32 v196, v196, s63, -v156
  v_exp_f32 v187, v187
  v_fma_f32 v197, v197, s63, -v156
  v_exp_f32 v196, v196
  v_fma_f32 v198, v198, s63, -v156
  v_exp_f32 v197, v197
  v_fma_f32 v199, v199, s63, -v156
  v_exp_f32 v198, v198
  v_cvt_pk_bf16_f32 v184, v184, v185
  v_exp_f32 v199, v199
  v_cvt_pk_bf16_f32 v185, v186, v187
  v_cvt_pk_bf16_f32 v186, v196, v197
  v_cvt_pk_bf16_f32 v187, v198, v199
  v_fma_f32 v188, v188, s63, -v157
  v_fma_f32 v189, v189, s63, -v157
  v_mfma_f32_16x16x32_bf16 v[172:175], v[148:151], v[184:187], v[172:175]
  v_exp_f32 v188, v188
  v_fma_f32 v190, v190, s63, -v157
  v_exp_f32 v189, v189
  ds_read_b32 v3, v30 offset:384
  v_fma_f32 v191, v191, s63, -v157
  v_exp_f32 v190, v190
  v_fma_f32 v200, v200, s63, -v157
  v_exp_f32 v191, v191
  v_fma_f32 v201, v201, s63, -v157
  v_exp_f32 v200, v200
  v_fma_f32 v202, v202, s63, -v157
  v_exp_f32 v201, v201
  v_fma_f32 v203, v203, s63, -v157
  v_exp_f32 v202, v202
  v_cvt_pk_bf16_f32 v188, v188, v189
  v_exp_f32 v203, v203
  s_waitcnt lgkmcnt(0)
  v_cmp_ne_u32 vcc, 0, v3
  v_cvt_pk_bf16_f32 v189, v190, v191
  v_cvt_pk_bf16_f32 v190, v200, v201
  v_cvt_pk_bf16_f32 v191, v202, v203
  v_fma_f32 v192, v192, s63, -v158
  v_fma_f32 v193, v193, s63, -v158
  v_mfma_f32_16x16x32_bf16 v[176:179], v[148:151], v[188:191], v[176:179]
  s_cbranch_vccnz LS_c10
LK_c10:
  ds_read_b64_tr_b16 v[132:133], v18 offset:40960
  ds_read_b64_tr_b16 v[134:135], v18 offset:45056
  ds_read_b64_tr_b16 v[136:137], v19 offset:40960
  ds_read_b64_tr_b16 v[138:139], v19 offset:45056
  ds_read_b64_tr_b16 v[8:9], v20 offset:40960
  ds_read_b64_tr_b16 v[10:11], v20 offset:45056
  ds_read_b64_tr_b16 v[12:13], v21 offset:40960
  ds_read_b64_tr_b16 v[14:15], v21 offset:45056
  v_exp_f32 v192, v192
  v_fma_f32 v194, v194, s63, -v158
  v_exp_f32 v193, v193
  v_fma_f32 v195, v195, s63, -v158
  v_exp_f32 v194, v194
  v_fma_f32 v204, v204, s63, -v158
  v_exp_f32 v195, v195
  v_fma_f32 v205, v205, s63, -v158
  s_waitcnt lgkmcnt(6)
  v_mfma_f32_16x16x32_bf16 v[36:39], v[132:135], v[160:163], 0
  v_exp_f32 v204, v204
  v_mfma_f32_16x16x32_bf16 v[68:71], v[132:135], v[164:167], 0
  v_fma_f32 v206, v206, s63, -v158
  v_exp_f32 v205, v205
  v_mfma_f32_16x16x32_bf16 v[100:103], v[132:135], v[168:171], 0
  s_waitcnt lgkmcnt(4)
  ds_read_b64_tr_b16 v[132:133], v22 offset:40960
  ds_read_b64_tr_b16 v[134:135], v22 offset:45056
  v_fma_f32 v207, v207, s63, -v158
  v_mfma_f32_16x16x32_bf16 v[40:43], v[136:139], v[160:163], 0
  v_exp_f32 v206, v206
  v_mfma_f32_16x16x32_bf16 v[72:75], v[136:139], v[164:167], 0
  v_cvt_pk_bf16_f32 v192, v192, v193
  v_exp_f32 v207, v207
  v_mfma_f32_16x16x32_bf16 v[104:107], v[136:139], v[168:171], 0
  s_waitcnt lgkmcnt(4)
  ds_read_b64_tr_b16 v[136:137], v23 offset:40960
  ds_read_b64_tr_b16 v[138:139], v23 offset:45056
  v_cvt_pk_bf16_f32 v193, v194, v195
  v_mfma_f32_16x16x32_bf16 v[44:47], v[8:11], v[160:163], 0
  v_cvt_pk_bf16_f32 v194, v204, v205
  v_cvt_pk_bf16_f32 v195, v206, v207
  v_mfma_f32_16x16x32_bf16 v[76:79], v[8:11], v[164:167], 0
  v_fma_f32 v208, v208, s63, -v156
  v_fma_f32 v209, v209, s63, -v156
  v_mfma_f32_16x16x32_bf16 v[180:183], v[148:151], v[192:195], v[180:183]
  v_exp_f32 v208, v208
  v_mfma_f32_16x16x32_bf16 v[108:111], v[8:11], v[168:171], 0
  s_waitcnt lgkmcnt(4)
  ds_read_b64_tr_b16 v[8:9], v24 offset:40960
  ds_read_b64_tr_b16 v[10:11], v24 offset:45056
  v_fma_f32 v210, v210, s63, -v156
  v_mfma_f32_16x16x32_bf16 v[48:51], v[12:15], v[160:163], 0
  v_exp_f32 v209, v209
  v_mfma_f32_16x16x32_bf16 v[80:83], v[12:15], v[164:167], 0
  v_fma_f32 v211, v211, s63, -v156
  v_exp_f32 v210, v210
  v_mfma_f32_16x16x32_bf16 v[112:115], v[12:15], v[168:171], 0
  s_waitcnt lgkmcnt(4)
  ds_read_b64_tr_b16 v[12:13], v25 offset:40960
  ds_read_b64_tr_b16 v[14:15], v25 offset:45056
  v_fma_f32 v220, v220, s63, -v156
  v_mfma_f32_16x16x32_bf16 v[52:55], v[132:135], v[160:163], 0
  v_exp_f32 v211, v211
  v_mfma_f32_16x16x32_bf16 v[84:87], v[132:135], v[164:167], 0
  ds_read_b32 v3, v30 offset:400
  v_fma_f32 v221, v221, s63, -v156
  v_mfma_f32_16x16x32_bf16 v[116:119], v[132:135], v[168:171], 0
  s_waitcnt lgkmcnt(5)
  v_exp_f32 v220, v220
  v_mfma_f32_16x16x32_bf16 v[56:59], v[136:139], v[160:163], 0
  v_fma_f32 v222, v222, s63, -v156
  v_exp_f32 v221, v221
  v_mfma_f32_16x16x32_bf16 v[88:91], v[136:139], v[164:167], 0
  v_fma_f32 v223, v223, s63, -v156
  v_exp_f32 v222, v222
  v_mfma_f32_16x16x32_bf16 v[120:123], v[136:139], v[168:171], 0
  s_waitcnt lgkmcnt(0)
  v_cmp_ne_u32 vcc, 0, v3
  v_cvt_pk_bf16_f32 v208, v208, v209
  v_mfma_f32_16x16x32_bf16 v[60:63], v[8:11], v[160:163], 0
  v_exp_f32 v223, v223
  v_mfma_f32_16x16x32_bf16 v[92:95], v[8:11], v[164:167], 0
  s_cbranch_vccnz LS_c11
LK_c11:
  ds_read_b64_tr_b16 v[132:133], v140 offset:0
  ds_read_b64_tr_b16 v[134:135], v140 offset:4096
  ds_read_b64_tr_b16 v[136:137], v141 offset:0
  ds_read_b64_tr_b16 v[138:139], v141 offset:4096
  v_cvt_pk_bf16_f32 v209, v210, v211
  v_mfma_f32_16x16x32_bf16 v[124:127], v[8:11], v[168:171], 0
  ds_read_b64_tr_b16 v[8:9], v142 offset:0
  ds_read_b64_tr_b16 v[10:11], v142 offset:4096
  v_cvt_pk_bf16_f32 v210, v220, v221
  v_mfma_f32_16x16x32_bf16 v[64:67], v[12:15], v[160:163], 0
  v_cvt_pk_bf16_f32 v211, v222, v223
  v_fma_f32 v212, v212, s63, -v157
  v_mfma_f32_16x16x32_bf16 v[96:99], v[12:15], v[164:167], 0
  v_fma_f32 v213, v213, s63, -v157
  v_mfma_f32_16x16x32_bf16 v[172:175], v[148:151], v[208:211], v[172:175]
  v_exp_f32 v212, v212
  v_mfma_f32_16x16x32_bf16 v[128:131], v[12:15], v[168:171], 0
  s_waitcnt lgkmcnt(4)
  ds_read_b64_tr_b16 v[12:13], v143 offset:0
  ds_read_b64_tr_b16 v[14:15], v143 offset:4096
  v_fma_f32 v214, v214, s63, -v157
  v_mfma_f32_16x16x32_bf16 v[36:39], v[132:135], v[184:187], v[36:39]
  v_exp_f32 v213, v213
  v_mfma_f32_16x16x32_bf16 v[68:71], v[132:135], v[188:191], v[68:71]
  v_fma_f32 v215, v215, s63, -v157
  v_exp_f32 v214, v214
  v_mfma_f32_16x16x32_bf16 v[100:103], v[132:135], v[192:195], v[100:103]
  s_waitcnt lgkmcnt(4)
  ds_read_b64_tr_b16 v[132:133], v144 offset:0
  ds_read_b64_tr_b16 v[134:135], v144 offset:4096
  v_fma_f32 v224, v224, s63, -v157
  v_mfma_f32_16x16x32_bf16 v[40:43], v[136:139], v[184:187], v[40:43]
  v_exp_f32 v215, v215
  v_mfma_f32_16x16x32_bf16 v[72:75], v[136:139], v[188:191], v[72:75]
  v_fma_f32 v225, v225, s63, -v157
  v_exp_f32 v224, v224
  v_mfma_f32_16x16x32_bf16 v[104:107], v[136:139], v[192:195], v[104:107]
  s_waitcnt lgkmcnt(4)
  ds_read_b64_tr_b16 v[136:137], v145 offset:0
  ds_read_b64_tr_b16 v[138:139], v145 offset:4096
  v_fma_f32 v226, v226, s63, -v157
  v_mfma_f32_16x16x32_bf16 v[44:47], v[8:11], v[184:187], v[44:47]
  v_exp_f32 v225, v225
  v_mfma_f32_16x16x32_bf16 v[76:79], v[8:11], v[188:191], v[76:79]
  v_fma_f32 v227, v227, s63, -v157
  v_exp_f32 v226, v226
  v_mfma_f32_16x16x32_bf16 v[108:111], v[8:11], v[192:195], v[108:111]
  s_waitcnt lgkmcnt(4)
  ds_read_b64_tr_b16 v[8:9], v146 offset:0
  ds_read_b64_tr_b16 v[10:11], v146 offset:4096
  v_cvt_pk_bf16_f32 v212, v212, v213
  v_mfma_f32_16x16x32_bf16 v[48:51], v[12:15], v[184:187], v[48:51]
  v_exp_f32 v227, v227
  v_mfma_f32_16x16x32_bf16 v[80:83], v[12:15], v[188:191], v[80:83]
  v_cvt_pk_bf16_f32 v213, v214, v215
  v_cvt_pk_bf16_f32 v214, v224, v225
  v_mfma_f32_16x16x32_bf16 v[112:115], v[12:15], v[192:195], v[112:115]
  s_waitcnt lgkmcnt(4)
  ds_read_b64_tr_b16 v[12:13], v147 offset:0
  ds_read_b64_tr_b16 v[14:15], v147 offset:4096
  v_cvt_pk_bf16_f32 v215, v226, v227
  v_mfma_f32_16x16x32_bf16 v[52:55], v[132:135], v[184:187], v[52:55]
  v_fma_f32 v216, v216, s63, -v158
  v_fma_f32 v217, v217, s63, -v158
  v_mfma_f32_16x16x32_bf16 v[176:179], v[148:151], v[212:215], v[176:179]
  v_exp_f32 v216, v216
  v_mfma_f32_16x16x32_bf16 v[84:87], v[132:135], v[188:191], v[84:87]
  v_fma_f32 v218, v218, s63, -v158
  v_exp_f32 v217, v217
  v_mfma_f32_16x16x32_bf16 v[116:119], v[132:135], v[192:195], v[116:119]
  s_waitcnt lgkmcnt(4)
  v_fma_f32 v219, v219, s63, -v158
  v_exp_f32 v218, v218
  v_mfma_f32_16x16x32_bf16 v[56:59], v[136:139], v[184:187], v[56:59]
  v_fma_f32 v228, v228, s63, -v158
  v_exp_f32 v219, v219
  v_mfma_f32_16x16x32_bf16 v[88:91], v[136:139], v[188:191], v[88:91]
  v_fma_f32 v229, v229, s63, -v158
  v_exp_f32 v228, v228
  v_mfma_f32_16x16x32_bf16 v[120:123], v[136:139], v[192:195], v[120:123]
  s_waitcnt lgkmcnt(2)
  ds_read_b32 v3, v30 offset:416
  v_fma_f32 v230, v230, s63, -v158
  v_mfma_f32_16x16x32_bf16 v[60:63], v[8:11], v[184:187], v[60:63]
  v_exp_f32 v229, v229
  v_mfma_f32_16x16x32_bf16 v[92:95], v[8:11], v[188:191], v[92:95]
  v_fma_f32 v231, v231, s63, -v158
  v_exp_f32 v230, v230
  v_mfma_f32_16x16x32_bf16 v[124:127], v[8:11], v[192:195], v[124:127]
  s_waitcnt lgkmcnt(1)
  v_cvt_pk_bf16_f32 v216, v216, v217
  v_exp_f32 v231, v231
  v_mfma_f32_16x16x32_bf16 v[64:67], v[12:15], v[184:187], v[64:67]
  s_waitcnt lgkmcnt(0)
  v_cmp_ne_u32 vcc, 0, v3
  v_cvt_pk_bf16_f32 v217, v218, v219
  v_mfma_f32_16x16x32_bf16 v[96:99], v[12:15], v[188:191], v[96:99]
  v_cvt_pk_bf16_f32 v218, v228, v229
  v_cvt_pk_bf16_f32 v219, v230, v231
  v_mfma_f32_16x16x32_bf16 v[128:131], v[12:15], v[192:195], v[128:131]
  s_cbranch_vccnz LS_c12
LK_c12:
  ds_read_b64_tr_b16 v[160:161], v140 offset:32768
  ds_read_b64_tr_b16 v[162:163], v140 offset:36864
  ds_read_b64_tr_b16 v[164:165], v141 offset:32768
  ds_read_b64_tr_b16 v[166:167], v141 offset:36864
  ds_read_b64_tr_b16 v[168:169], v142 offset:32768
  ds_read_b64_tr_b16 v[170:171], v142 offset:36864
  ds_read_b64_tr_b16 v[196:197], v143 offset:32768
  ds_read_b64_tr_b16 v[198:199], v143 offset:36864
  ds_read_b64_tr_b16 v[200:201], v144 offset:32768
  ds_read_b64_tr_b16 v[202:203], v144 offset:36864
  ds_read_b64_tr_b16 v[204:205], v145 offset:32768
  v_fma_f32 v232, v232, s63, -v156
  v_fma_f32 v233, v233, s63, -v156
  v_mfma_f32_16x16x32_bf16 v[180:183], v[148:151], v[216:219], v[180:183]
  ds_read_b64_tr_b16 v[206:207], v145 offset:36864
  ds_read_b64_tr_b16 v[220:221], v146 offset:32768
  ds_read_b64_tr_b16 v[222:223], v146 offset:36864
  ds_read_b64_tr_b16 v[224:225], v147 offset:32768
  v_exp_f32 v232, v232
  s_waitcnt lgkmcnt(13)
  v_mfma_f32_16x16x32_bf16 v[36:39], v[160:163], v[208:211], v[36:39]
  s_waitcnt lgkmcnt(11)
  ds_read_b64_tr_b16 v[226:227], v147 offset:36864
  ds_read_b32 v3, v30 offset:32
  v_fma_f32 v234, v234, s63, -v156
  v_mfma_f32_16x16x32_bf16 v[40:43], v[164:167], v[208:211], v[40:43]
  s_waitcnt lgkmcnt(11)
  v_exp_f32 v233, v233
  v_mfma_f32_16x16x32_bf16 v[44:47], v[168:171], v[208:211], v[44:47]
  s_waitcnt lgkmcnt(9)
  v_fma_f32 v235, v235, s63, -v156
  v_exp_f32 v234, v234
  v_mfma_f32_16x16x32_bf16 v[48:51], v[196:199], v[208:211], v[48:51]
  s_waitcnt lgkmcnt(7)
  v_fma_f32 v244, v244, s63, -v156
  v_exp_f32 v235, v235
  v_mfma_f32_16x16x32_bf16 v[52:55], v[200:203], v[208:211], v[52:55]
  s_waitcnt lgkmcnt(5)
  v_fma_f32 v245, v245, s63, -v156
  v_exp_f32 v244, v244
  v_mfma_f32_16x16x32_bf16 v[56:59], v[204:207], v[208:211], v[56:59]
  s_waitcnt lgkmcnt(3)
  v_fma_f32 v246, v246, s63, -v156
  v_exp_f32 v245, v245
  v_mfma_f32_16x16x32_bf16 v[60:63], v[220:223], v[208:211], v[60:63]
  s_waitcnt lgkmcnt(0)
  v_cmp_ne_u32 vcc, 0, v3
  v_fma_f32 v247, v247, s63, -v156
  v_mfma_f32_16x16x32_bf16 v[64:67], v[224:227], v[208:211], v[64:67]
  v_exp_f32 v246, v246
  v_cvt_pk_bf16_f32 v232, v232, v233
  s_cbranch_vccnz LS_c13
LK_c13:
  ds_read_b64_tr_b16 v[132:133], v140 offset:49152
  ds_read_b64_tr_b16 v[134:135], v140 offset:53248
  ds_read_b64_tr_b16 v[136:137], v141 offset:49152
  ds_read_b64_tr_b16 v[138:139], v141 offset:53248
  ds_read_b64_tr_b16 v[8:9], v142 offset:49152
  ds_read_b64_tr_b16 v[10:11], v142 offset:53248
  ds_read_b64_tr_b16 v[12:13], v143 offset:49152
  ds_read_b64_tr_b16 v[14:15], v143 offset:53248
  ds_read_b64_tr_b16 v[184:185], v144 offset:49152
  ds_read_b64_tr_b16 v[186:187], v144 offset:53248
  ds_read_b64_tr_b16 v[188:189], v145 offset:49152
  v_exp_f32 v247, v247
  v_cvt_pk_bf16_f32 v233, v234, v235
  v_cvt_pk_bf16_f32 v234, v244, v245
  v_cvt_pk_bf16_f32 v235, v246, v247
  v_fma_f32 v236, v236, s63, -v157
  v_fma_f32 v237, v237, s63, -v157
  v_mfma_f32_16x16x32_bf16 v[172:175], v[148:151], v[232:235], v[172:175]
  ds_read_b64_tr_b16 v[190:191], v145 offset:53248
  ds_read_b64_tr_b16 v[192:193], v146 offset:49152
  ds_read_b64_tr_b16 v[194:195], v146 offset:53248
  ds_read_b64_tr_b16 v[228:229], v147 offset:49152
  ds_read_b64_tr_b16 v[230:231], v147 offset:53248
  v_exp_f32 v236, v236
  s_waitcnt lgkmcnt(14)
  v_mfma_f32_16x16x32_bf16 v[36:39], v[132:135], v[232:235], v[36:39]
  s_waitcnt lgkmcnt(12)
  v_fma_f32 v238, v238, s63, -v157
  v_exp_f32 v237, v237
  v_mfma_f32_16x16x32_bf16 v[40:43], v[136:139], v[232:235], v[40:43]
  s_waitcnt lgkmcnt(10)
  v_fma_f32 v239, v239, s63, -v157
  v_exp_f32 v238, v238
  v_mfma_f32_16x16x32_bf16 v[44:47], v[8:11], v[232:235], v[44:47]
  s_waitcnt lgkmcnt(8)
  v_fma_f32 v248, v248, s63, -v157
  v_exp_f32 v239, v239
  v_mfma_f32_16x16x32_bf16 v[48:51], v[12:15], v[232:235], v[48:51]
  s_waitcnt lgkmcnt(6)
  ds_write_b128 v2, v[36:39] offset:0
  v_fma_f32 v249, v249, s63, -v157
  v_mfma_f32_16x16x32_bf16 v[52:55], v[184:187], v[232:235], v[52:55]
  s_waitcnt lgkmcnt(5)
  ds_write_b128 v2, v[40:43] offset:1024
  v_mov_b32 v172, v156
  v_mfma_f32_16x16x32_bf16 v[56:59], v[188:191], v[232:235], v[56:59]
  s_waitcnt lgkmcnt(4)
  v_or_b32 v173, 1, v173
  v_exp_f32 v248, v248
  v_mfma_f32_16x16x32_bf16 v[60:63], v[192:195], v[232:235], v[60:63]
  s_waitcnt lgkmcnt(2)
  ds_write_b64 v31, v[172:173] offset:0
  v_fma_f32 v250, v250, s63, -v157
  v_mfma_f32_16x16x32_bf16 v[64:67], v[228:231], v[232:235], v[64:67]
  v_exp_f32 v249, v249
  v_mfma_f32_16x16x32_bf16 v[68:71], v[160:163], v[212:215], v[68:71]
  v_fma_f32 v251, v251, s63, -v157
  v_exp_f32 v250, v250
  v_mfma_f32_16x16x32_bf16 v[72:75], v[164:167], v[212:215], v[72:75]
  ds_write_b128 v2, v[44:47] offset:2048
  v_cvt_pk_bf16_f32 v236, v236, v237
  v_mfma_f32_16x16x32_bf16 v[76:79], v[168:171], v[212:215], v[76:79]
  v_exp_f32 v251, v251
  v_mfma_f32_16x16x32_bf16 v[80:83], v[196:199], v[212:215], v[80:83]
  ds_write_b128 v2, v[48:51] offset:3072
  v_cvt_pk_bf16_f32 v237, v238, v239
  v_mfma_f32_16x16x32_bf16 v[84:87], v[200:203], v[212:215], v[84:87]
  v_cvt_pk_bf16_f32 v238, v248, v249
  v_cvt_pk_bf16_f32 v239, v250, v251
  v_mfma_f32_16x16x32_bf16 v[88:91], v[204:207], v[212:215], v[88:91]
  ds_write_b128 v2, v[52:55] offset:4096
  v_fma_f32 v240, v240, s63, -v158
  v_mfma_f32_16x16x32_bf16 v[92:95], v[220:223], v[212:215], v[92:95]
  v_fma_f32 v241, v241, s63, -v158
  v_mfma_f32_16x16x32_bf16 v[176:179], v[148:151], v[236:239], v[176:179]
  v_exp_f32 v240, v240
  v_mfma_f32_16x16x32_bf16 v[96:99], v[224:227], v[212:215], v[96:99]
  ds_write_b128 v2, v[56:59] offset:5120
  v_fma_f32 v242, v242, s63, -v158
  v_mfma_f32_16x16x32_bf16 v[68:71], v[132:135], v[236:239], v[68:71]
  v_exp_f32 v241, v241
  v_mfma_f32_16x16x32_bf16 v[72:75], v[136:139], v[236:239], v[72:75]
  ds_write_b128 v2, v[60:63] offset:6144
  v_mov_b32 v176, v157
  v_mfma_f32_16x16x32_bf16 v[76:79], v[8:11], v[236:239], v[76:79]
  v_or_b32 v177, 1, v177
  v_fma_f32 v243, v243, s63, -v158
  v_mfma_f32_16x16x32_bf16 v[80:83], v[12:15], v[236:239], v[80:83]
  ds_write_b64 v31, v[176:177] offset:512
  v_exp_f32 v242, v242
  v_mfma_f32_16x16x32_bf16 v[84:87], v[184:187], v[236:239], v[84:87]
  ds_write_b128 v2, v[64:67] offset:7168
  v_fma_f32 v252, v252, s63, -v158
  v_mfma_f32_16x16x32_bf16 v[88:91], v[188:191], v[236:239], v[88:91]
  ds_write_b32 v32, v4 offset:512
  v_exp_f32 v243, v243
  v_mfma_f32_16x16x32_bf16 v[92:95], v[192:195], v[236:239], v[92:95]
  ds_write_b128 v2, v[68:71] offset:8192
  v_fma_f32 v253, v253, s63, -v158
  v_mfma_f32_16x16x32_bf16 v[96:99], v[228:231], v[236:239], v[96:99]
  ds_write_b128 v2, v[72:75] offset:9216
  v_exp_f32 v252, v252
  v_mfma_f32_16x16x32_bf16 v[100:103], v[160:163], v[216:219], v[100:103]
  v_fma_f32 v254, v254, s63, -v158
  v_exp_f32 v253, v253
  v_mfma_f32_16x16x32_bf16 v[104:107], v[164:167], v[216:219], v[104:107]
  ds_write_b128 v2, v[76:79] offset:10240
  v_fma_f32 v255, v255, s63, -v158
  v_mfma_f32_16x16x32_bf16 v[108:111], v[168:171], v[216:219], v[108:111]
  v_exp_f32 v254, v254
  v_mfma_f32_16x16x32_bf16 v[112:115], v[196:199], v[216:219], v[112:115]
  ds_write_b128 v2, v[80:83] offset:11264
  v_cvt_pk_bf16_f32 v240, v240, v241
  v_mfma_f32_16x16x32_bf16 v[116:119], v[200:203], v[216:219], v[116:119]
  v_exp_f32 v255, v255
  v_mfma_f32_16x16x32_bf16 v[120:123], v[204:207], v[216:219], v[120:123]
  v_cvt_pk_bf16_f32 v241, v242, v243
  v_cvt_pk_bf16_f32 v242, v252, v253
  v_mfma_f32_16x16x32_bf16 v[124:127], v[220:223], v[216:219], v[124:127]
  v_cvt_pk_bf16_f32 v243, v254, v255
  v_mfma_f32_16x16x32_bf16 v[128:131], v[224:227], v[216:219], v[128:131]
  s_nop 0
  v_mfma_f32_16x16x32_bf16 v[180:183], v[148:151], v[240:243], v[180:183]
  v_mfma_f32_16x16x32_bf16 v[100:103], v[132:135], v[240:243], v[100:103]
  v_mfma_f32_16x16x32_bf16 v[104:107], v[136:139], v[240:243], v[104:107]
  v_mfma_f32_16x16x32_bf16 v[108:111], v[8:11], v[240:243], v[108:111]
  v_mfma_f32_16x16x32_bf16 v[112:115], v[12:15], v[240:243], v[112:115]
  v_mfma_f32_16x16x32_bf16 v[116:119], v[184:187], v[240:243], v[116:119]
  s_nop 2
  v_mov_b32 v180, v158
  v_mfma_f32_16x16x32_bf16 v[120:123], v[188:191], v[240:243], v[120:123]
  v_or_b32 v181, 1, v181
  v_mfma_f32_16x16x32_bf16 v[124:127], v[192:195], v[240:243], v[124:127]
  ds_write_b64 v31, v[180:181] offset:1024
  v_mfma_f32_16x16x32_bf16 v[128:131], v[228:231], v[240:243], v[128:131]
  ds_write_b128 v2, v[84:87] offset:12288
  ds_write_b128 v2, v[88:91] offset:13312
  ds_write_b128 v2, v[92:95] offset:14336
  ds_write_b128 v2, v[96:99] offset:15360
  ds_write_b32 v32, v4 offset:768
  ds_write_b128 v2, v[100:103] offset:16384
  ds_write_b128 v2, v[104:107] offset:17408
  ds_write_b128 v2, v[108:111] offset:18432
  ds_write_b128 v2, v[112:115] offset:19456
  ds_write_b128 v2, v[116:119] offset:20480
  ds_write_b128 v2, v[120:123] offset:21504
  ds_write_b128 v2, v[124:127] offset:22528
  ds_write_b128 v2, v[128:131] offset:23552
  ds_write_b32 v32, v4 offset:1024
  ds_add_u32 v32, v4
  ds_add_u32 v32, v4
  ds_add_u32 v32, v4
  s_waitcnt lgkmcnt(0)
  s_branch L_ophase
LS_c1:
  ds_read_b32 v3, v30 offset:0
  s_waitcnt lgkmcnt(0)
  v_cmp_ne_u32 vcc, 0, v3
  s_sub_u32 s99, s99, 1
  s_cbranch_scc1 L_end
  s_cbranch_vccnz LS_c1
  s_branch LK_c1
LS_c2:
  ds_read_b32 v3, v30 offset:400
  s_waitcnt lgkmcnt(0)
  v_cmp_ne_u32 vcc, 0, v3
  s_sub_u32 s99, s99, 1
  s_cbranch_scc1 L_end
  s_cbranch_vccnz LS_c2
  s_branch LK_c2
LS_c3:
  ds_read_b32 v3, v30 offset:16
  s_waitcnt lgkmcnt(0)
  v_cmp_ne_u32 vcc, 0, v3
  s_sub_u32 s99, s99, 1
  s_cbranch_scc1 L_end
  s_cbranch_vccnz LS_c3
  s_branch LK_c3
LS_c4:
  ds_read_b32 v3, v30 offset:416
  s_waitcnt lgkmcnt(0)
  v_cmp_ne_u32 vcc, 0, v3
  s_sub_u32 s99, s99, 1
  s_cbranch_scc1 L_end
  s_cbranch_vccnz LS_c4
  s_branch LK_c4
LS_c5:
  ds_read_b32 v3, v30 offset:32
  s_waitcnt lgkmcnt(0)
  v_cmp_ne_u32 vcc, 0, v3
  s_sub_u32 s99, s99, 1
  s_cbranch_scc1 L_end
  s_cbranch_vccnz LS_c5
  s_branch LK_c5
LS_c6:
  ds_read_b32 v3, v30 offset:432
  s_waitcnt lgkmcnt(0)
  v_cmp_ne_u32 vcc, 0, v3
  s_sub_u32 s99, s99, 1
  s_cbranch_scc1 L_end
  s_cbranch_vccnz LS_c6
  s_branch LK_c6
LS_c7:
  ds_read_b32 v3, v30 offset:48
  s_waitcnt lgkmcnt(0)
  v_cmp_ne_u32 vcc, 0, v3
  s_sub_u32 s99, s99, 1
  s_cbranch_scc1 L_end
  s_cbranch_vccnz LS_c7
  s_branch LK_c7
LS_c8:
  ds_read_b64 v[152:153], v31
  s_waitcnt lgkmcnt(0)
  v_cmp_eq_u32 vcc, 0, v153
  s_sub_u32 s99, s99, 1
  s_cbranch_scc1 L_end
  s_cbranch_vccnz LS_c8
  s_branch LK_c8
LS_c9:
  ds_read_b32 v3, v32 offset:1280
  ds_read_b128 v[160:163], v34 offset:0
  ds_read_b128 v[164:167], v34 offset:1024
  ds_read_b128 v[168:171], v34 offset:2048
  ds_read_b128 v[172:175], v34 offset:3072
  ds_read_b128 v[176:179], v34 offset:4096
  ds_read_b128 v[180:183], v34 offset:5120
  ds_read_b128 v[184:187], v34 offset:6144
  ds_read_b128 v[188:191], v34 offset:7168
  s_waitcnt lgkmcnt(8)
  v_cmp_eq_u32 vcc, 0, v3
  s_sub_u32 s99, s99, 1
  s_cbranch_scc1 L_end
  s_cbranch_vccnz LS_c9
  s_waitcnt lgkmcnt(0)
  s_branch LK_c9
LS_c10:
  ds_read_b32 v3, v30 offset:384
  s_waitcnt lgkmcnt(0)
  v_cmp_ne_u32 vcc, 0, v3
  s_sub_u32 s99, s99, 1
  s_cbranch_scc1 L_end
  s_cbranch_vccnz LS_c10
  s_branch LK_c10
LS_c11:
  ds_read_b32 v3, v30 offset:400
  s_waitcnt lgkmcnt(0)
  v_cmp_ne_u32 vcc, 0, v3
  s_sub_u32 s99, s99, 1
  s_cbranch_scc1 L_end
  s_cbranch_vccnz LS_c11
  s_branch LK_c11
LS_c12:
  ds_read_b32 v3, v30 offset:416
  s_waitcnt lgkmcnt(0)
  v_cmp_ne_u32 vcc, 0, v3
  s_sub_u32 s99, s99, 1
  s_cbranch_scc1 L_end
  s_cbranch_vccnz LS_c12
  s_branch LK_c12
LS_c13:
  ds_read_b32 v3, v30 offset:32
  s_waitcnt lgkmcnt(0)
  v_cmp_ne_u32 vcc, 0, v3
  s_sub_u32 s99, s99, 1
  s_cbranch_scc1 L_end
  s_cbranch_vccnz LS_c13
  s_branch LK_c13
LS_c18:
  ds_read_b32 v3, v30 offset:160
  s_waitcnt lgkmcnt(0)
  v_cmp_ne_u32 vcc, 0, v3
  s_sub_u32 s99, s99, 1
  s_cbranch_scc1 L_end
  s_cbranch_vccnz LS_c18
  s_branch LK_c18
LS_c19:
  ds_read_b32 v3, v30 offset:176
  s_waitcnt lgkmcnt(0)
  v_cmp_ne_u32 vcc, 0, v3
  s_sub_u32 s99, s99, 1
  s_cbranch_scc1 L_end
  s_cbranch_vccnz LS_c19
  s_branch LK_c19
LS_c20:
  ds_read_b32 v3, v30 offset:112
  s_waitcnt lgkmcnt(0)
  v_cmp_ne_u32 vcc, 0, v3
  s_sub_u32 s99, s99, 1
  s_cbranch_scc1 L_end
  s_cbranch_vccnz LS_c20
  s_branch LK_c20
LS_c21:
  ds_read_b32 v3, v30 offset:192
  s_waitcnt lgkmcnt(0)
  v_cmp_ne_u32 vcc, 0, v3
  s_sub_u32 s99, s99, 1
  s_cbranch_scc1 L_end
  s_cbranch_vccnz LS_c21
  s_branch LK_c21
LS_c22:
  ds_read_b32 v3, v30 offset:208
  s_waitcnt lgkmcnt(0)
  v_cmp_ne_u32 vcc, 0, v3
  s_sub_u32 s99, s99, 1
  s_cbranch_scc1 L_end
  s_cbranch_vccnz LS_c22
  s_branch LK_c22
LS_c23:
  ds_read_b32 v3, v30 offset:224
  s_waitcnt lgkmcnt(0)
  v_cmp_ne_u32 vcc, 0, v3
  s_sub_u32 s99, s99, 1
  s_cbranch_scc1 L_end
  s_cbranch_vccnz LS_c23
  s_branch LK_c23
LS_c24:
  ds_read_b32 v3, v30 offset:240
  s_waitcnt lgkmcnt(0)
  v_cmp_ne_u32 vcc, 0, v3
  s_sub_u32 s99, s99, 1
  s_cbranch_scc1 L_end
  s_cbranch_vccnz LS_c24
  s_branch LK_c24
LS_c25:
  ds_read_b32 v3, v30 offset:256
  s_waitcnt lgkmcnt(0)
  v_cmp_ne_u32 vcc, 0, v3
  s_sub_u32 s99, s99, 1
  s_cbranch_scc1 L_end
  s_cbranch_vccnz LS_c25
  s_branch LK_c25
L_codeend:
.section .rodata,"a"
.p2align 6
.amdhsa_kernel standalone__gqa_block_cached__near_ridge_kernel
  .amdhsa_next_free_vgpr 256
  .amdhsa_next_free_sgpr 102
  .amdhsa_accum_offset 256
  .amdhsa_group_segment_fixed_size 0
  .amdhsa_kernarg_size 64
  .amdhsa_user_sgpr_count 2
  .amdhsa_user_sgpr_kernarg_segment_ptr 1
  .amdhsa_system_sgpr_workgroup_id_x 1
  .amdhsa_float_denorm_mode_32 3
.end_amdhsa_kernel
```
